```python
import torch

def _softmax(x, axis=-1):
    return torch.softmax(x, dim=axis)
def _gelu(x):
    return torch.nn.functional.gelu(x, approximate="tanh")
def _silu(x):
    return torch.nn.functional.silu(x)
def _sigmoid(x):
    return torch.sigmoid(x)
def _layernorm(x, axis=-1, eps=1e-5):
    m = x.mean(dim=axis, keepdim=True)
    v = x.var(dim=axis, keepdim=True, unbiased=False)
    return (x - m) / torch.sqrt(v + eps)
def _scatter_add(tgt, idx, src, axis=0):
    return tgt.clone().index_add_(axis, idx, src)
def _segment_sum(src, seg, n):
    out = torch.zeros((n,) + src.shape[1:], dtype=src.dtype)
    return out.index_add_(0, seg, src)
def _pad(x, pw):
    flat = tuple(v for pair in reversed(pw) for v in pair)
    return torch.nn.functional.pad(x, flat)

kernel_name = 'gated_mix__ssm_conv_s5__dense_activation_relu__prompt'

def setup_inputs():

    _w = (lambda a: (lambda t: t.to(torch.bfloat16) if t.is_floating_point() else t)(torch.as_tensor(a)))
    def _A_setup():
        B, S, D = 1, 2048, 1024
        P = D
        Lambda_re = -0.5 * (lambda _x: torch.exp(torch.as_tensor(_x)))((lambda *s: torch.randn(*s, dtype=torch.bfloat16) * 0.8)(P))
        Lambda_im = (lambda *s: torch.randn(*s, dtype=torch.bfloat16) * 0.8)(P) * 1.0
        B_re = (lambda *s: torch.randn(*s, dtype=torch.bfloat16) * 0.8)(P, D) * (D ** -0.5)
        B_im = (lambda *s: torch.randn(*s, dtype=torch.bfloat16) * 0.8)(P, D) * (D ** -0.5)
        C_re = (lambda *s: torch.randn(*s, dtype=torch.bfloat16) * 0.8)(D, P) * (P ** -0.5)
        C_im = (lambda *s: torch.randn(*s, dtype=torch.bfloat16) * 0.8)(D, P) * (P ** -0.5)
        log_dt = (lambda *s: torch.randn(*s, dtype=torch.bfloat16) * 0.8)(P) * 0.3 - 2.0
        Dskip = (lambda *s: torch.randn(*s, dtype=torch.bfloat16) * 0.8)(D)
        return {
            "x": _w((lambda *s: torch.randn(*s, dtype=torch.bfloat16) * 0.05)(B, S, D)),
            "Lambda_re": _w(Lambda_re),
            "Lambda_im": _w(Lambda_im),
            "B_re": _w(B_re),
            "B_im": _w(B_im),
            "C_re": _w(C_re),
            "C_im": _w(C_im),
            "log_dt": _w(log_dt),
            "Dskip": _w(Dskip),
        }
    _A_in = _A_setup()

    def _B_setup():
        B, S, D, Dff = 1, 2048, 1024, 3584
        return {
            "x": _w((lambda *s: torch.randn(*s, dtype=torch.bfloat16) * 0.05)(B, S, D)),
            "w1": _w((lambda *s: torch.randn(*s, dtype=torch.bfloat16) * 0.05)(D, Dff)),
            "w2": _w((lambda *s: torch.randn(*s, dtype=torch.bfloat16) * 0.05)(Dff, D)),
        }
    _B_in = _B_setup()

    return {
        "A_x": _A_in["x"],
        "A_Lambda_re": _A_in["Lambda_re"],
        "A_Lambda_im": _A_in["Lambda_im"],
        "A_B_re": _A_in["B_re"],
        "A_B_im": _A_in["B_im"],
        "A_C_re": _A_in["C_re"],
        "A_C_im": _A_in["C_im"],
        "A_log_dt": _A_in["log_dt"],
        "A_Dskip": _A_in["Dskip"],
        "B_x": _B_in["x"],
        "B_w1": _B_in["w1"],
        "B_w2": _B_in["w2"],
        "gate_w": _w((lambda *s: torch.randn(*s, dtype=torch.bfloat16) * 0.05)(1024) * 16.0),
    }

def reference(A_x, A_Lambda_re, A_Lambda_im, A_B_re, A_B_im, A_C_re, A_C_im, A_log_dt, A_Dskip, B_x, B_w1, B_w2, gate_w):
    def _A_ref(x, Lambda_re, Lambda_im, B_re, B_im, C_re, C_im, log_dt, Dskip):
        Bsz, L, H = x.shape
        Lam = Lambda_re + 1j * Lambda_im
        Bmat = B_re + 1j * B_im
        Cmat = C_re + 1j * C_im
        dt = torch.exp(log_dt)
        Lam_bar = torch.exp(dt * Lam)
        B_bar = ((Lam_bar - 1.0) / Lam)[:, None] * Bmat
        Bu = torch.einsum("bld,pd->blp", x + 0j, B_bar)
        h = torch.zeros_like(Bu[:, 0, :])
        hs = []
        for t in range(L):
            h = Lam_bar[None, :] * h + Bu[:, t, :]
            hs.append(h)
        hseq = torch.stack(hs, 1)
        y = 2.0 * torch.einsum("blp,dp->bld", hseq, Cmat).real + x * Dskip[None, None, :]
        return y

    def _B_ref(x, w1, w2):
        h = torch.einsum("bsd,df->bsf", x, w1)
        zero = torch.zeros_like(h)
        h = torch.maximum(h, zero)
        return torch.einsum("bsf,fd->bsd", h, w2)

    x = A_x
    g = _sigmoid((x * gate_w).sum(-1, keepdims=True))
    a = _A_ref(x, A_Lambda_re, A_Lambda_im, A_B_re, A_B_im, A_C_re, A_C_im, A_log_dt, A_Dskip)
    b = _B_ref(x, B_w1, B_w2)
    return g * a + (1 - g) * b
```

```asm
; @launch grid=(256,1,1) block=(512,1,1) lds=162048
.amdgcn_target "amdgcn-amd-amdhsa--gfx950"
.text
.globl gated_mix__ssm_conv_s5__dense_activation_relu__prompt_kernel
.p2align 8
.type gated_mix__ssm_conv_s5__dense_activation_relu__prompt_kernel,@function
gated_mix__ssm_conv_s5__dense_activation_relu__prompt_kernel:
    s_cmp_ge_u32 s2, 256
    s_cbranch_scc1 k1_end
    s_load_dwordx16 s[32:47], s[0:1], 0
    s_load_dwordx16 s[48:63], s[0:1], 64
    v_lshrrev_b32 v1, 6, v0
    v_and_b32 v0, 63, v0
    v_readfirstlane_b32 s64, v1
    s_nop 0
    s_and_b32 s65, s64, 3
    s_lshr_b32 s66, s64, 2
    v_lshrrev_b32 v30, 3, v0
    v_and_b32 v31, 7, v0
    v_and_b32 v32, 15, v0
    v_lshrrev_b32 v33, 4, v0
    s_lshr_b32 s80, s64, 1
    s_lshl_b32 s80, s80, 6
    s_and_b32 s81, s64, 1
    s_lshl_b32 s82, s81, 3
    s_add_u32 s80, s80, s82
    v_lshrrev_b32 v34, 2, v30
    v_lshlrev_b32 v34, 4, v34
    v_and_b32 v35, 3, v30
    v_add3_u32 v34, v34, v35, s80
    v_lshlrev_b32 v34, 11, v34
    v_lshrrev_b32 v35, 1, v30
    v_xor_b32 v35, v35, v31
    v_lshl_add_u32 v1, v35, 4, v34
    v_xor_b32 v2, 64, v1
    v_add_u32 v2, 0x10000, v2
    v_add_u32 v3, 0x2000, v1
    v_add_u32 v4, 0x2000, v2
    s_lshl_b32 s83, s66, 4
    s_lshl_b32 s82, s81, 3
    s_add_u32 s82, s82, s83
    v_add_u32 v34, s82, v30
    v_lshlrev_b32 v34, 11, v34
    s_lshl_b32 s82, s81, 2
    v_xor_b32 v35, s82, v35
    v_lshl_add_u32 v5, v35, 4, v34
    s_lshl_b32 s82, s64, 6
    s_movk_i32 s85, 4682
    s_movk_i32 s86, 7168
    v_add_u32 v34, s82, v0
    v_mul_lo_u32 v35, v34, s85
    v_lshrrev_b32 v35, 16, v35
    v_mul_u32_u24 v36, 14, v35
    v_sub_u32 v36, v34, v36
    v_and_b32 v37, 0x33, v35
    v_and_b32 v38, 4, v35
    v_lshl_or_b32 v37, v38, 1, v37
    v_and_b32 v38, 8, v35
    v_lshrrev_b32 v38, 1, v38
    v_or_b32 v37, v37, v38
    v_mul_lo_u32 v37, v37, s86
    v_lshl_add_u32 v6, v36, 4, v37
    s_add_u32 s82, s82, 512
    v_add_u32 v34, s82, v0
    v_mul_lo_u32 v35, v34, s85
    v_lshrrev_b32 v35, 16, v35
    v_mul_u32_u24 v36, 14, v35
    v_sub_u32 v36, v34, v36
    v_and_b32 v37, 0x33, v35
    v_and_b32 v38, 4, v35
    v_lshl_or_b32 v37, v38, 1, v37
    v_and_b32 v38, 8, v35
    v_lshrrev_b32 v38, 1, v38
    v_or_b32 v37, v37, v38
    v_mul_lo_u32 v37, v37, s86
    v_lshl_add_u32 v7, v36, 4, v37
    s_add_u32 s82, s82, 512
    v_mov_b32 v35, 0x80000000
    v_cmp_lt_u32 vcc, 895, v34
    s_nop 1
    v_cndmask_b32 v7, v7, v35, vcc
    s_lshl_b32 s73, s64, 12
    s_add_u32 s73, s73, 16384
    s_add_u32 s100, s73, 1024
    s_add_u32 s101, s73, 2048
    s_add_u32 s78, s73, 3072
    s_lshl_b32 s82, s64, 10
    s_add_u32 s74, s82, 0
    s_add_u32 s75, s82, 49152
    s_add_u32 s76, s82, 57344
    s_sub_u32 s82, s82, 6144
    s_add_u32 s82, s82, 157696
    s_cmp_ge_u32 s64, 6
    s_cselect_b32 s76, s82, s76
    s_cselect_b32 s77, 0, 1
    v_mov_b32 v42, 161792
    v_mov_b32 v40, 0
    ds_write_b32 v42, v40
    s_mov_b32 s79, s2
    s_waitcnt lgkmcnt(0)
    s_and_b32 s80, s79, 7
    s_lshr_b32 s79, s79, 3
    s_and_b32 s67, s80, 1
    s_lshl_b32 s67, s67, 2
    s_and_b32 s81, s79, 3
    s_add_u32 s67, s67, s81
    s_lshr_b32 s68, s80, 1
    s_lshl_b32 s68, s68, 3
    s_lshr_b32 s81, s79, 2
    s_add_u32 s68, s68, s81
    s_lshl_b32 s70, s67, 19
    s_lshl_b32 s72, s68, 16
    s_mul_i32 s71, s68, 224
    s_lshl_b32 s81, s68, 5
    s_add_u32 s83, s83, s81
    s_mov_b32 s28, s60
    s_mov_b32 s29, s61
    s_mov_b32 s30, 256
    s_mov_b32 s31, 0x00020000
    s_or_b32 s80, s2, s64
    s_cmp_lg_u32 s80, 0
    s_cbranch_scc1 k1_nonon
    s_memrealtime s[80:81]
    v_mov_b32 v35, 0
    s_waitcnt lgkmcnt(0)
    s_or_b32 s80, s80, 1
    v_mov_b32 v36, s80
    s_mov_b64 exec, 1
    buffer_store_dword v36, v35, s[28:31], 0 offen sc1
    s_mov_b64 exec, -1
k1_nonon:
    s_mov_b32 s4, s32
    s_mov_b32 s5, s33
    s_mov_b32 s6, 4194304
    s_mov_b32 s7, 0x00020000
    s_bitcmp1_b32 s64, 1
    s_cselect_b64 s[8:9], s[40:41], s[38:39]
    s_mov_b32 s10, 2097152
    s_mov_b32 s11, 0x00020000
    s_mov_b32 s12, s52
    s_mov_b32 s13, s53
    s_mov_b32 s14, 7340032
    s_mov_b32 s15, 0x00020000
    s_mov_b32 s16, s62
    s_mov_b32 s17, s63
    s_mov_b32 s18, 268435456
    s_mov_b32 s19, 0x00020000
    s_mov_b32 s20, s56
    s_mov_b32 s21, s57
    s_mov_b32 s22, 2048
    s_mov_b32 s23, 0x00020000
    s_mov_b32 s93, 0
    s_mov_b32 s94, 0
    s_add_u32 m0, s94, s74
    s_nop 0
    buffer_load_dwordx4 v5, s[8:11], s72 offen  lds
    s_add_u32 s72, s72, 128
    s_add_u32 m0, s93, s73
    s_nop 0
    buffer_load_dwordx4 v1, s[4:7], s70 offen  lds
    s_add_u32 m0, s93, s100
    s_nop 0
    buffer_load_dwordx4 v2, s[4:7], s70 offen  lds
    s_add_u32 m0, s93, s101
    s_nop 0
    buffer_load_dwordx4 v3, s[4:7], s70 offen  lds
    s_add_u32 m0, s93, s78
    s_nop 0
    buffer_load_dwordx4 v4, s[4:7], s70 offen  lds
    s_add_u32 m0, s93, s75
    s_add_u32 s70, s70, 128
    buffer_load_dwordx4 v6, s[12:15], s71 offen  lds
    s_mul_i32 s97, s93, s77
    s_add_u32 m0, s97, s76
    s_nop 0
    buffer_load_dwordx4 v7, s[12:15], s71 offen  lds
    s_add_u32 s71, s71, 458752
    s_cmp_eq_u32 s64, 5
    s_cselect_b64 s[24:25], s[42:43], s[54:55]
    s_cmp_eq_u32 s64, 6
    s_cselect_b64 s[24:25], s[44:45], s[24:25]
    s_mov_b32 s27, 0x00020000
    s_mul_i32 s80, s2, 5
    s_add_u32 s80, s80, s64
    s_lshl_b32 s80, s80, 9
    s_lshl_b32 s81, s2, 10
    s_cmp_lt_u32 s64, 5
    s_cselect_b32 s79, s80, s81
    s_mov_b32 s92, 262144
    s_cselect_b32 s92, 655360, s92
    s_mov_b32 s26, 2097152
    s_cselect_b32 s26, 7340032, s26
    s_cselect_b32 s80, 3, 4
    s_cmp_eq_u32 s64, 7
    s_cselect_b32 s26, 0, s26
    v_lshlrev_b32 v36, s80, v0
    v_and_b32 v37, 15, v0
    v_lshrrev_b32 v34, 1, v37
    v_xor_b32 v34, v34, v33
    v_lshlrev_b32 v34, 4, v34
    v_lshl_add_u32 v34, v37, 7, v34
    s_lshl_b32 s80, s65, 13
    s_add_u32 s80, s80, 16384
    v_add_u32 v8, s80, v34
    v_xor_b32 v9, 64, v8
    s_lshl_b32 s80, s66, 12
    s_add_u32 s80, s80, 0
    v_add_u32 v10, s80, v34
    v_xor_b32 v11, 64, v10
    v_lshrrev_b32 v34, 1, v33
    v_lshlrev_b32 v34, 4, v34
    v_and_b32 v35, 1, v33
    v_lshl_add_u32 v34, v35, 2, v34
    v_bfe_u32 v35, v0, 2, 2
    v_add_u32 v34, v34, v35
    v_mul_u32_u24 v34, 224, v34
    v_and_b32 v35, 3, v0
    v_lshl_add_u32 v34, v35, 3, v34
    s_and_b32 s88, s68, 1
    s_cmp_eq_u32 s88, 1
    s_cselect_b32 s89, 48, 0
    s_cselect_b32 s97, 16, 64
    s_cselect_b32 s91, 0, 96
    s_cmp_eq_u32 s66, 0
    s_cselect_b32 s89, s89, s97
    s_lshl_b32 s80, s89, 1
    s_add_u32 s80, s80, 49152
    v_add_u32 v12, s80, v34
    s_lshl_b32 s80, s91, 1
    s_add_u32 s80, s80, 49152
    v_add_u32 v13, s80, v34
    s_lshl_b32 s80, s65, 2
    v_add_u32 v26, s80, v33
    s_mov_b32 s93, 47104
    s_mov_b32 s94, 0x2000
    s_add_u32 m0, s94, s74
    s_nop 0
    buffer_load_dwordx4 v5, s[8:11], s72 offen  lds
    s_add_u32 s72, s72, 128
    s_add_u32 m0, s93, s73
    s_nop 0
    buffer_load_dwordx4 v1, s[4:7], s70 offen  lds
    s_add_u32 m0, s93, s100
    s_nop 0
    buffer_load_dwordx4 v2, s[4:7], s70 offen  lds
    s_add_u32 m0, s93, s101
    s_nop 0
    buffer_load_dwordx4 v3, s[4:7], s70 offen  lds
    s_add_u32 m0, s93, s78
    s_nop 0
    buffer_load_dwordx4 v4, s[4:7], s70 offen  lds
    s_add_u32 m0, s93, s75
    s_add_u32 s70, s70, 128
    buffer_load_dwordx4 v6, s[12:15], s71 offen  lds
    s_mul_i32 s97, s93, s77
    s_add_u32 m0, s97, s76
    s_nop 0
    buffer_load_dwordx4 v7, s[12:15], s71 offen  lds
    s_add_u32 s71, s71, 458752
    s_mov_b32 s93, 94208
    s_mov_b32 s94, 0
    s_mov_b32 s96, 0
    s_mov_b32 s95, 47104
    v_mov_b32 v50, v8
    v_mov_b32 v51, v9
    v_mov_b32 v52, v10
    v_mov_b32 v53, v11
    v_mov_b32 v54, v12
    v_mov_b32 v55, v13
    s_waitcnt vmcnt(7) lgkmcnt(0)
    s_barrier
    s_mov_b32 s69, 0
    s_cmp_eq_u32 s66, 1
    s_cbranch_scc1 k1_c1
    ds_read_b128 v[160:163], v50 offset:0
    ds_read_b128 v[176:179], v52 offset:0
    ds_read_b128 v[164:167], v50 offset:2048
    ds_read_b128 v[168:171], v50 offset:4096
    ds_read_b128 v[172:175], v50 offset:6144
    ds_read_b128 v[180:183], v52 offset:2048
    ds_read_b64_tr_b16 v[184:185], v54 offset:0
    ds_read_b64_tr_b16 v[186:187], v54 offset:1792
    ds_read_b64_tr_b16 v[188:189], v54 offset:32
    ds_read_b64_tr_b16 v[190:191], v54 offset:1824
    ds_read_b64_tr_b16 v[192:193], v54 offset:64
    ds_read_b64_tr_b16 v[194:195], v54 offset:1856
    ds_read_b64_tr_b16 v[196:197], v54 offset:96
    ds_read_b64_tr_b16 v[198:199], v54 offset:1888
    s_waitcnt lgkmcnt(0)
    v_mfma_f32_16x16x32_bf16 v[64:67], v[160:163], v[176:179], 0
    ds_read_b128 v[200:203], v51 offset:0
    s_add_u32 m0, s93, s73
    s_nop 0
    buffer_load_dwordx4 v1, s[4:7], s70 offen  lds
    v_mfma_f32_16x16x32_bf16 v[68:71], v[164:167], v[176:179], 0
    ds_read_b128 v[216:219], v53 offset:0
    v_mfma_f32_16x16x32_bf16 v[72:75], v[168:171], v[176:179], 0
    ds_read_b128 v[204:207], v51 offset:2048
    v_mfma_f32_16x16x32_bf16 v[76:79], v[172:175], v[176:179], 0
    ds_read_b128 v[208:211], v51 offset:4096
    v_mfma_f32_16x16x32_bf16 v[80:83], v[160:163], v[180:183], 0
    ds_read_b128 v[212:215], v51 offset:6144
    s_add_u32 m0, s93, s100
    s_nop 0
    buffer_load_dwordx4 v2, s[4:7], s70 offen  lds
    v_mfma_f32_16x16x32_bf16 v[84:87], v[164:167], v[180:183], 0
    ds_read_b128 v[220:223], v53 offset:2048
    v_mfma_f32_16x16x32_bf16 v[88:91], v[168:171], v[180:183], 0
    ds_read_b64_tr_b16 v[224:225], v54 offset:7168
    v_mfma_f32_16x16x32_bf16 v[92:95], v[172:175], v[180:183], 0
    ds_read_b64_tr_b16 v[226:227], v54 offset:8960
    s_add_u32 m0, s93, s101
    s_nop 0
    buffer_load_dwordx4 v3, s[4:7], s70 offen  lds
    v_mfma_f32_16x16x32_bf16 v[96:99], v[184:187], v[160:163], 0
    ds_read_b64_tr_b16 v[228:229], v54 offset:7200
    v_mfma_f32_16x16x32_bf16 v[100:103], v[184:187], v[164:167], 0
    ds_read_b64_tr_b16 v[230:231], v54 offset:8992
    v_mfma_f32_16x16x32_bf16 v[104:107], v[184:187], v[168:171], 0
    ds_read_b64_tr_b16 v[232:233], v54 offset:7232
    s_add_u32 m0, s93, s78
    s_nop 0
    buffer_load_dwordx4 v4, s[4:7], s70 offen  lds
    v_mfma_f32_16x16x32_bf16 v[108:111], v[184:187], v[172:175], 0
    ds_read_b64_tr_b16 v[234:235], v54 offset:9024
    v_mfma_f32_16x16x32_bf16 v[112:115], v[188:191], v[160:163], 0
    ds_read_b64_tr_b16 v[236:237], v54 offset:7264
    v_mfma_f32_16x16x32_bf16 v[116:119], v[188:191], v[164:167], 0
    ds_read_b64_tr_b16 v[238:239], v54 offset:9056
    v_mfma_f32_16x16x32_bf16 v[120:123], v[188:191], v[168:171], 0
    s_add_u32 m0, s93, s75
    s_add_u32 s70, s70, 128
    buffer_load_dwordx4 v6, s[12:15], s71 offen  lds
    v_mfma_f32_16x16x32_bf16 v[124:127], v[188:191], v[172:175], 0
    v_mfma_f32_16x16x32_bf16 v[128:131], v[192:195], v[160:163], 0
    v_mfma_f32_16x16x32_bf16 v[132:135], v[192:195], v[164:167], 0
    s_mul_i32 s97, s93, s77
    s_add_u32 m0, s97, s76
    s_nop 0
    buffer_load_dwordx4 v7, s[12:15], s71 offen  lds
    s_add_u32 s71, s71, 458752
    v_mfma_f32_16x16x32_bf16 v[136:139], v[192:195], v[168:171], 0
    v_mfma_f32_16x16x32_bf16 v[140:143], v[192:195], v[172:175], 0
    v_mfma_f32_16x16x32_bf16 v[144:147], v[196:199], v[160:163], 0
    v_mfma_f32_16x16x32_bf16 v[148:151], v[196:199], v[164:167], 0
    s_lshl_b32 s85, s67, 8
    s_lshl_b32 s87, s68, 3
    s_add_u32 s87, s87, s85
    s_add_u32 s87, s87, s64
    s_lshl_b32 s85, s87, 11
    v_lshlrev_b32 v40, 5, v0
    buffer_load_dwordx4 v[240:243], v40, s[4:7], s85 offen
    buffer_load_dwordx4 v[244:247], v40, s[4:7], s85 offen offset:16
    buffer_load_dwordx4 v[248:251], v40, s[20:23], 0 offen
    buffer_load_dwordx4 v[252:255], v40, s[20:23], 0 offen offset:16
    v_and_b32 v41, 15, v0
    v_add_u32 v37, s83, v41
    v_lshlrev_b32 v37, 1, v37
    v_and_b32 v38, 31, v0
    s_lshl_b32 s85, s68, 5
    v_add_u32 v38, s85, v38
    v_lshlrev_b32 v38, 1, v38
    s_mov_b32 s28, s34
    s_mov_b32 s29, s35
    s_mov_b32 s30, 2048
    s_mov_b32 s31, 0x00020000
    buffer_load_ushort v27, v37, s[28:31], 0 offen
    buffer_load_ushort v30, v38, s[28:31], 0 offen
    s_nop 0
    s_mov_b32 s28, s36
    s_mov_b32 s29, s37
    s_mov_b32 s30, 2048
    s_mov_b32 s31, 0x00020000
    buffer_load_ushort v28, v37, s[28:31], 0 offen
    buffer_load_ushort v31, v38, s[28:31], 0 offen
    s_nop 0
    s_mov_b32 s28, s46
    s_mov_b32 s29, s47
    s_mov_b32 s30, 2048
    s_mov_b32 s31, 0x00020000
    buffer_load_ushort v29, v37, s[28:31], 0 offen
    buffer_load_ushort v32, v38, s[28:31], 0 offen
    s_nop 0
    v_mfma_f32_16x16x32_bf16 v[152:155], v[196:199], v[168:171], 0
    v_mfma_f32_16x16x32_bf16 v[156:159], v[196:199], v[172:175], 0
    s_waitcnt vmcnt(16) lgkmcnt(0)
    s_barrier
    s_mov_b32 s93, s96
    s_mov_b32 s96, s95
    v_add_u32 v50, s95, v8
    v_xor_b32 v52, 0x2000, v52
    v_add_u32 v54, s95, v12
    v_add_u32 v55, s95, v13
    v_mfma_f32_16x16x32_bf16 v[64:67], v[200:203], v[216:219], v[64:67]
    ds_read_b128 v[160:163], v50 offset:0
    v_add_u32 v51, s95, v9
    v_xor_b32 v53, 0x2000, v53
    v_mfma_f32_16x16x32_bf16 v[68:71], v[204:207], v[216:219], v[68:71]
    ds_read_b128 v[176:179], v52 offset:0
    s_add_u32 m0, s94, s74
    s_nop 0
    buffer_load_dwordx4 v5, s[8:11], s72 offen  lds
    s_add_u32 s72, s72, 128
    s_xor_b32 s94, s94, 0x2000
    s_add_u32 m0, s93, s73
    s_nop 0
    buffer_load_dwordx4 v1, s[4:7], s70 offen  lds
    v_mfma_f32_16x16x32_bf16 v[72:75], v[208:211], v[216:219], v[72:75]
    ds_read_b128 v[164:167], v50 offset:2048
    s_add_u32 s95, s95, 47104
    s_cmp_lt_u32 s95, 141312
    s_cselect_b32 s95, s95, 0
    v_mfma_f32_16x16x32_bf16 v[76:79], v[212:215], v[216:219], v[76:79]
    ds_read_b128 v[168:171], v50 offset:4096
    v_mfma_f32_16x16x32_bf16 v[80:83], v[200:203], v[220:223], v[80:83]
    ds_read_b128 v[172:175], v50 offset:6144
    v_mfma_f32_16x16x32_bf16 v[84:87], v[204:207], v[220:223], v[84:87]
    ds_read_b128 v[180:183], v52 offset:2048
    v_mfma_f32_16x16x32_bf16 v[88:91], v[208:211], v[220:223], v[88:91]
    ds_read_b64_tr_b16 v[184:185], v54 offset:0
    v_mfma_f32_16x16x32_bf16 v[92:95], v[212:215], v[220:223], v[92:95]
    ds_read_b64_tr_b16 v[186:187], v54 offset:1792
    s_add_u32 m0, s93, s100
    s_nop 0
    buffer_load_dwordx4 v2, s[4:7], s70 offen  lds
    v_mfma_f32_16x16x32_bf16 v[96:99], v[224:227], v[200:203], v[96:99]
    ds_read_b64_tr_b16 v[188:189], v54 offset:32
    v_mfma_f32_16x16x32_bf16 v[100:103], v[224:227], v[204:207], v[100:103]
    ds_read_b64_tr_b16 v[190:191], v54 offset:1824
    v_mfma_f32_16x16x32_bf16 v[104:107], v[224:227], v[208:211], v[104:107]
    ds_read_b64_tr_b16 v[192:193], v54 offset:64
    v_mfma_f32_16x16x32_bf16 v[108:111], v[224:227], v[212:215], v[108:111]
    ds_read_b64_tr_b16 v[194:195], v54 offset:1856
    v_mfma_f32_16x16x32_bf16 v[112:115], v[228:231], v[200:203], v[112:115]
    ds_read_b64_tr_b16 v[196:197], v54 offset:96
    v_mfma_f32_16x16x32_bf16 v[116:119], v[228:231], v[204:207], v[116:119]
    ds_read_b64_tr_b16 v[198:199], v54 offset:1888
    s_add_u32 m0, s93, s101
    s_nop 0
    buffer_load_dwordx4 v3, s[4:7], s70 offen  lds
    v_mfma_f32_16x16x32_bf16 v[120:123], v[228:231], v[208:211], v[120:123]
    v_mfma_f32_16x16x32_bf16 v[124:127], v[228:231], v[212:215], v[124:127]
    v_mfma_f32_16x16x32_bf16 v[128:131], v[232:235], v[200:203], v[128:131]
    v_mfma_f32_16x16x32_bf16 v[132:135], v[232:235], v[204:207], v[132:135]
    v_mfma_f32_16x16x32_bf16 v[136:139], v[232:235], v[208:211], v[136:139]
    v_mfma_f32_16x16x32_bf16 v[140:143], v[232:235], v[212:215], v[140:143]
    buffer_load_dword v49, v36, s[24:27], s79 offen
    s_add_u32 s79, s79, s92
    v_mfma_f32_16x16x32_bf16 v[144:147], v[236:239], v[200:203], v[144:147]
    v_mfma_f32_16x16x32_bf16 v[148:151], v[236:239], v[204:207], v[148:151]
    v_mfma_f32_16x16x32_bf16 v[152:155], v[236:239], v[208:211], v[152:155]
    v_mfma_f32_16x16x32_bf16 v[156:159], v[236:239], v[212:215], v[156:159]
k1_loop0:
    s_waitcnt lgkmcnt(0)
    v_mfma_f32_16x16x32_bf16 v[64:67], v[160:163], v[176:179], v[64:67]
    ds_read_b128 v[200:203], v51 offset:0
    v_mfma_f32_16x16x32_bf16 v[68:71], v[164:167], v[176:179], v[68:71]
    ds_read_b128 v[216:219], v53 offset:0
    s_add_u32 m0, s93, s78
    s_nop 0
    buffer_load_dwordx4 v4, s[4:7], s70 offen  lds
    v_mfma_f32_16x16x32_bf16 v[72:75], v[168:171], v[176:179], v[72:75]
    ds_read_b128 v[204:207], v51 offset:2048
    v_mfma_f32_16x16x32_bf16 v[76:79], v[172:175], v[176:179], v[76:79]
    ds_read_b128 v[208:211], v51 offset:4096
    v_mfma_f32_16x16x32_bf16 v[80:83], v[160:163], v[180:183], v[80:83]
    ds_read_b128 v[212:215], v51 offset:6144
    v_mfma_f32_16x16x32_bf16 v[84:87], v[164:167], v[180:183], v[84:87]
    ds_read_b128 v[220:223], v53 offset:2048
    v_mfma_f32_16x16x32_bf16 v[88:91], v[168:171], v[180:183], v[88:91]
    ds_read_b64_tr_b16 v[224:225], v54 offset:7168
    v_mfma_f32_16x16x32_bf16 v[92:95], v[172:175], v[180:183], v[92:95]
    ds_read_b64_tr_b16 v[226:227], v54 offset:8960
    v_mfma_f32_16x16x32_bf16 v[96:99], v[184:187], v[160:163], v[96:99]
    ds_read_b64_tr_b16 v[228:229], v54 offset:7200
    v_mfma_f32_16x16x32_bf16 v[100:103], v[184:187], v[164:167], v[100:103]
    ds_read_b64_tr_b16 v[230:231], v54 offset:8992
    s_add_u32 m0, s93, s75
    s_add_u32 s70, s70, 128
    buffer_load_dwordx4 v6, s[12:15], s71 offen  lds
    v_mfma_f32_16x16x32_bf16 v[104:107], v[184:187], v[168:171], v[104:107]
    ds_read_b64_tr_b16 v[232:233], v54 offset:7232
    v_mfma_f32_16x16x32_bf16 v[108:111], v[184:187], v[172:175], v[108:111]
    ds_read_b64_tr_b16 v[234:235], v54 offset:9024
    v_mfma_f32_16x16x32_bf16 v[112:115], v[188:191], v[160:163], v[112:115]
    ds_read_b64_tr_b16 v[236:237], v54 offset:7264
    v_mfma_f32_16x16x32_bf16 v[116:119], v[188:191], v[164:167], v[116:119]
    ds_read_b64_tr_b16 v[238:239], v54 offset:9056
    v_mfma_f32_16x16x32_bf16 v[120:123], v[188:191], v[168:171], v[120:123]
    v_mfma_f32_16x16x32_bf16 v[124:127], v[188:191], v[172:175], v[124:127]
    v_mfma_f32_16x16x32_bf16 v[128:131], v[192:195], v[160:163], v[128:131]
    v_mfma_f32_16x16x32_bf16 v[132:135], v[192:195], v[164:167], v[132:135]
    s_mul_i32 s97, s93, s77
    s_add_u32 m0, s97, s76
    s_nop 0
    buffer_load_dwordx4 v7, s[12:15], s71 offen  lds
    s_add_u32 s71, s71, 458752
    v_mfma_f32_16x16x32_bf16 v[136:139], v[192:195], v[168:171], v[136:139]
    v_mfma_f32_16x16x32_bf16 v[140:143], v[192:195], v[172:175], v[140:143]
    v_mfma_f32_16x16x32_bf16 v[144:147], v[196:199], v[160:163], v[144:147]
    v_mfma_f32_16x16x32_bf16 v[148:151], v[196:199], v[164:167], v[148:151]
    v_mfma_f32_16x16x32_bf16 v[152:155], v[196:199], v[168:171], v[152:155]
    v_mfma_f32_16x16x32_bf16 v[156:159], v[196:199], v[172:175], v[156:159]
    s_waitcnt vmcnt(7) lgkmcnt(0)
    s_barrier
    s_mov_b32 s93, s96
    s_mov_b32 s96, s95
    v_add_u32 v50, s95, v8
    v_xor_b32 v52, 0x2000, v52
    v_add_u32 v54, s95, v12
    v_add_u32 v55, s95, v13
    v_mfma_f32_16x16x32_bf16 v[64:67], v[200:203], v[216:219], v[64:67]
    ds_read_b128 v[160:163], v50 offset:0
    v_add_u32 v51, s95, v9
    v_xor_b32 v53, 0x2000, v53
    v_mfma_f32_16x16x32_bf16 v[68:71], v[204:207], v[216:219], v[68:71]
    ds_read_b128 v[176:179], v52 offset:0
    s_add_u32 m0, s94, s74
    s_nop 0
    buffer_load_dwordx4 v5, s[8:11], s72 offen  lds
    s_add_u32 s72, s72, 128
    s_xor_b32 s94, s94, 0x2000
    s_add_u32 m0, s93, s73
    s_nop 0
    buffer_load_dwordx4 v1, s[4:7], s70 offen  lds
    v_mfma_f32_16x16x32_bf16 v[72:75], v[208:211], v[216:219], v[72:75]
    ds_read_b128 v[164:167], v50 offset:2048
    s_add_u32 s95, s95, 47104
    s_cmp_lt_u32 s95, 141312
    s_cselect_b32 s95, s95, 0
    v_mfma_f32_16x16x32_bf16 v[76:79], v[212:215], v[216:219], v[76:79]
    ds_read_b128 v[168:171], v50 offset:4096
    v_mfma_f32_16x16x32_bf16 v[80:83], v[200:203], v[220:223], v[80:83]
    ds_read_b128 v[172:175], v50 offset:6144
    v_mfma_f32_16x16x32_bf16 v[84:87], v[204:207], v[220:223], v[84:87]
    ds_read_b128 v[180:183], v52 offset:2048
    v_mfma_f32_16x16x32_bf16 v[88:91], v[208:211], v[220:223], v[88:91]
    ds_read_b64_tr_b16 v[184:185], v54 offset:0
    v_mfma_f32_16x16x32_bf16 v[92:95], v[212:215], v[220:223], v[92:95]
    ds_read_b64_tr_b16 v[186:187], v54 offset:1792
    s_add_u32 m0, s93, s100
    s_nop 0
    buffer_load_dwordx4 v2, s[4:7], s70 offen  lds
    v_mfma_f32_16x16x32_bf16 v[96:99], v[224:227], v[200:203], v[96:99]
    ds_read_b64_tr_b16 v[188:189], v54 offset:32
    v_mfma_f32_16x16x32_bf16 v[100:103], v[224:227], v[204:207], v[100:103]
    ds_read_b64_tr_b16 v[190:191], v54 offset:1824
    v_mfma_f32_16x16x32_bf16 v[104:107], v[224:227], v[208:211], v[104:107]
    ds_read_b64_tr_b16 v[192:193], v54 offset:64
    v_mfma_f32_16x16x32_bf16 v[108:111], v[224:227], v[212:215], v[108:111]
    ds_read_b64_tr_b16 v[194:195], v54 offset:1856
    v_mfma_f32_16x16x32_bf16 v[112:115], v[228:231], v[200:203], v[112:115]
    ds_read_b64_tr_b16 v[196:197], v54 offset:96
    v_mfma_f32_16x16x32_bf16 v[116:119], v[228:231], v[204:207], v[116:119]
    ds_read_b64_tr_b16 v[198:199], v54 offset:1888
    s_add_u32 m0, s93, s101
    s_nop 0
    buffer_load_dwordx4 v3, s[4:7], s70 offen  lds
    v_mfma_f32_16x16x32_bf16 v[120:123], v[228:231], v[208:211], v[120:123]
    v_mfma_f32_16x16x32_bf16 v[124:127], v[228:231], v[212:215], v[124:127]
    v_mfma_f32_16x16x32_bf16 v[128:131], v[232:235], v[200:203], v[128:131]
    v_mfma_f32_16x16x32_bf16 v[132:135], v[232:235], v[204:207], v[132:135]
    v_mfma_f32_16x16x32_bf16 v[136:139], v[232:235], v[208:211], v[136:139]
    v_mfma_f32_16x16x32_bf16 v[140:143], v[232:235], v[212:215], v[140:143]
    buffer_load_dword v49, v36, s[24:27], s79 offen
    s_add_u32 s79, s79, s92
    v_mfma_f32_16x16x32_bf16 v[144:147], v[236:239], v[200:203], v[144:147]
    v_mfma_f32_16x16x32_bf16 v[148:151], v[236:239], v[204:207], v[148:151]
    v_mfma_f32_16x16x32_bf16 v[152:155], v[236:239], v[208:211], v[152:155]
    v_mfma_f32_16x16x32_bf16 v[156:159], v[236:239], v[212:215], v[156:159]
    s_add_u32 s69, s69, 1
    s_cmp_lt_u32 s69, 12
    s_cbranch_scc1 k1_loop0
    s_waitcnt lgkmcnt(0)
    v_mfma_f32_16x16x32_bf16 v[64:67], v[160:163], v[176:179], v[64:67]
    v_lshlrev_b32 v27, 16, v27
    v_lshlrev_b32 v28, 16, v28
    ds_read_b128 v[200:203], v51 offset:0
    v_mfma_f32_16x16x32_bf16 v[68:71], v[164:167], v[176:179], v[68:71]
    v_lshlrev_b32 v29, 16, v29
    v_mul_f32 v29, 1069066811, v29
    ds_read_b128 v[216:219], v53 offset:0
    s_add_u32 m0, s93, s78
    s_nop 0
    buffer_load_dwordx4 v4, s[4:7], s70 offen  lds
    v_mfma_f32_16x16x32_bf16 v[72:75], v[168:171], v[176:179], v[72:75]
    v_exp_f32 v29, v29
    s_nop 0
    v_cvt_pk_bf16_f32 v29, v29, v29
    ds_read_b128 v[204:207], v51 offset:2048
    v_mfma_f32_16x16x32_bf16 v[76:79], v[172:175], v[176:179], v[76:79]
    v_lshlrev_b32 v29, 16, v29
    v_mul_f32 v42, v29, v27
    ds_read_b128 v[208:211], v51 offset:4096
    v_mfma_f32_16x16x32_bf16 v[80:83], v[160:163], v[180:183], v[80:83]
    v_mul_f32 v43, v29, v28
    v_mul_f32 v42, 1069066811, v42
    ds_read_b128 v[212:215], v51 offset:6144
    v_mfma_f32_16x16x32_bf16 v[84:87], v[164:167], v[180:183], v[84:87]
    v_mul_f32 v43, 1042479491, v43
    v_lshlrev_b32 v30, 16, v30
    ds_read_b128 v[220:223], v53 offset:2048
    v_mfma_f32_16x16x32_bf16 v[88:91], v[168:171], v[180:183], v[88:91]
    v_lshlrev_b32 v31, 16, v31
    v_lshlrev_b32 v32, 16, v32
    ds_read_b64_tr_b16 v[224:225], v54 offset:7168
    v_mfma_f32_16x16x32_bf16 v[92:95], v[172:175], v[180:183], v[92:95]
    v_mul_f32 v32, 1069066811, v32
    v_exp_f32 v32, v32
    ds_read_b64_tr_b16 v[226:227], v54 offset:8960
    v_mfma_f32_16x16x32_bf16 v[96:99], v[184:187], v[160:163], v[96:99]
    v_cvt_pk_bf16_f32 v32, v32, v32
    v_lshlrev_b32 v32, 16, v32
    ds_read_b64_tr_b16 v[228:229], v54 offset:7200
    v_mfma_f32_16x16x32_bf16 v[100:103], v[184:187], v[164:167], v[100:103]
    v_mul_f32 v44, v32, v30
    v_mul_f32 v45, v32, v31
    ds_read_b64_tr_b16 v[230:231], v54 offset:8992
    s_add_u32 m0, s93, s75
    s_add_u32 s70, s70, 128
    buffer_load_dwordx4 v6, s[12:15], s71 offen  lds
    v_mfma_f32_16x16x32_bf16 v[104:107], v[184:187], v[168:171], v[104:107]
    v_mul_f32 v44, 1069066811, v44
    v_mul_f32 v45, 1042479491, v45
    ds_read_b64_tr_b16 v[232:233], v54 offset:7232
    v_mfma_f32_16x16x32_bf16 v[108:111], v[184:187], v[172:175], v[108:111]
    v_mul_f32 v46, 1.0, v42
    v_mul_f32 v47, 1.0, v43
    ds_read_b64_tr_b16 v[234:235], v54 offset:9024
    v_mfma_f32_16x16x32_bf16 v[112:115], v[188:191], v[160:163], v[112:115]
    v_exp_f32 v46, v46
    v_fract_f32 v47, v47
    ds_read_b64_tr_b16 v[236:237], v54 offset:7264
    v_mfma_f32_16x16x32_bf16 v[116:119], v[188:191], v[164:167], v[116:119]
    v_cos_f32 v14, v47
    v_sin_f32 v15, v47
    ds_read_b64_tr_b16 v[238:239], v54 offset:9056
    v_mfma_f32_16x16x32_bf16 v[120:123], v[188:191], v[168:171], v[120:123]
    v_mul_f32 v14, v14, v46
    v_mul_f32 v15, v15, v46
    v_mfma_f32_16x16x32_bf16 v[124:127], v[188:191], v[172:175], v[124:127]
    s_mov_b32 s85, 0x41800000
    s_mov_b32 s86, 0x43800000
    v_mfma_f32_16x16x32_bf16 v[128:131], v[192:195], v[160:163], v[128:131]
    v_cvt_f32_u32 v39, v26
    v_mul_f32 v39, s85, v39
    v_mfma_f32_16x16x32_bf16 v[132:135], v[192:195], v[164:167], v[132:135]
    s_mul_i32 s97, s93, s77
    s_add_u32 m0, s97, s76
    s_nop 0
    buffer_load_dwordx4 v7, s[12:15], s71 offen  lds
    s_add_u32 s71, s71, 458752
    v_mfma_f32_16x16x32_bf16 v[136:139], v[192:195], v[168:171], v[136:139]
    v_mfma_f32_16x16x32_bf16 v[140:143], v[192:195], v[172:175], v[140:143]
    v_mfma_f32_16x16x32_bf16 v[144:147], v[196:199], v[160:163], v[144:147]
    v_mfma_f32_16x16x32_bf16 v[148:151], v[196:199], v[164:167], v[148:151]
    v_mfma_f32_16x16x32_bf16 v[152:155], v[196:199], v[168:171], v[152:155]
    v_mfma_f32_16x16x32_bf16 v[156:159], v[196:199], v[172:175], v[156:159]
    s_waitcnt vmcnt(7) lgkmcnt(0)
    s_barrier
    s_mov_b32 s93, s96
    s_mov_b32 s96, s95
    v_add_u32 v50, s95, v8
    v_xor_b32 v52, 0x2000, v52
    v_add_u32 v54, s95, v12
    v_add_u32 v55, s95, v13
    v_mfma_f32_16x16x32_bf16 v[64:67], v[200:203], v[216:219], v[64:67]
    v_mul_f32 v46, s85, v42
    v_mul_f32 v47, s85, v43
    ds_read_b128 v[160:163], v50 offset:0
    v_add_u32 v51, s95, v9
    v_xor_b32 v53, 0x2000, v53
    v_mfma_f32_16x16x32_bf16 v[68:71], v[204:207], v[216:219], v[68:71]
    v_exp_f32 v46, v46
    v_fract_f32 v47, v47
    ds_read_b128 v[176:179], v52 offset:0
    s_add_u32 m0, s94, s74
    s_nop 0
    buffer_load_dwordx4 v5, s[8:11], s72 offen  lds
    s_add_u32 s72, s72, 128
    s_xor_b32 s94, s94, 0x2000
    v_mfma_f32_16x16x32_bf16 v[72:75], v[208:211], v[216:219], v[72:75]
    v_cos_f32 v16, v47
    v_sin_f32 v17, v47
    ds_read_b128 v[164:167], v50 offset:2048
    s_add_u32 s95, s95, 47104
    s_cmp_lt_u32 s95, 141312
    s_cselect_b32 s95, s95, 0
    v_mfma_f32_16x16x32_bf16 v[76:79], v[212:215], v[216:219], v[76:79]
    v_mul_f32 v16, v16, v46
    v_mul_f32 v17, v17, v46
    ds_read_b128 v[168:171], v50 offset:4096
    v_mfma_f32_16x16x32_bf16 v[80:83], v[200:203], v[220:223], v[80:83]
    v_lshrrev_b32 v34, 4, v0
    v_sub_u32 v35, 6, v34
    ds_read_b128 v[172:175], v50 offset:6144
    v_mfma_f32_16x16x32_bf16 v[84:87], v[204:207], v[220:223], v[84:87]
    v_cvt_f32_u32 v35, v35
    v_mul_f32 v35, s86, v35
    ds_read_b128 v[180:183], v52 offset:2048
    v_mfma_f32_16x16x32_bf16 v[88:91], v[208:211], v[220:223], v[88:91]
    v_mul_f32 v46, v35, v42
    v_mul_f32 v47, v35, v43
    ds_read_b64_tr_b16 v[184:185], v54 offset:0
    v_mfma_f32_16x16x32_bf16 v[92:95], v[212:215], v[220:223], v[92:95]
    v_exp_f32 v46, v46
    v_fract_f32 v47, v47
    ds_read_b64_tr_b16 v[186:187], v54 offset:1792
    v_mfma_f32_16x16x32_bf16 v[96:99], v[224:227], v[200:203], v[96:99]
    v_cos_f32 v18, v47
    v_sin_f32 v19, v47
    ds_read_b64_tr_b16 v[188:189], v54 offset:32
    v_mfma_f32_16x16x32_bf16 v[100:103], v[224:227], v[204:207], v[100:103]
    v_mul_f32 v18, v18, v46
    v_mul_f32 v19, v19, v46
    ds_read_b64_tr_b16 v[190:191], v54 offset:1824
    v_mfma_f32_16x16x32_bf16 v[104:107], v[224:227], v[208:211], v[104:107]
    v_add_f32 v35, 0xc4800000, v35
    v_max_f32 v37, 0, v35
    ds_read_b64_tr_b16 v[192:193], v54 offset:64
    v_mfma_f32_16x16x32_bf16 v[108:111], v[224:227], v[212:215], v[108:111]
    v_mul_f32 v46, v37, v42
    v_mul_f32 v47, v37, v43
    ds_read_b64_tr_b16 v[194:195], v54 offset:1856
    v_mfma_f32_16x16x32_bf16 v[112:115], v[228:231], v[200:203], v[112:115]
    v_exp_f32 v46, v46
    v_fract_f32 v47, v47
    ds_read_b64_tr_b16 v[196:197], v54 offset:96
    v_mfma_f32_16x16x32_bf16 v[116:119], v[228:231], v[204:207], v[116:119]
    v_cos_f32 v34, v47
    v_sin_f32 v35, v47
    ds_read_b64_tr_b16 v[198:199], v54 offset:1888
    v_mfma_f32_16x16x32_bf16 v[120:123], v[228:231], v[208:211], v[120:123]
    v_mul_f32 v34, v34, v46
    v_mul_f32 v35, v35, v46
    v_mfma_f32_16x16x32_bf16 v[124:127], v[228:231], v[212:215], v[124:127]
    v_mul_f32 v46, v39, v42
    v_mul_f32 v47, v39, v43
    v_mfma_f32_16x16x32_bf16 v[128:131], v[232:235], v[200:203], v[128:131]
    v_exp_f32 v46, v46
    v_fract_f32 v47, v47
    v_mfma_f32_16x16x32_bf16 v[132:135], v[232:235], v[204:207], v[132:135]
    v_mfma_f32_16x16x32_bf16 v[136:139], v[232:235], v[208:211], v[136:139]
    v_mfma_f32_16x16x32_bf16 v[140:143], v[232:235], v[212:215], v[140:143]
    v_mfma_f32_16x16x32_bf16 v[144:147], v[236:239], v[200:203], v[144:147]
    v_mfma_f32_16x16x32_bf16 v[148:151], v[236:239], v[204:207], v[148:151]
    v_mfma_f32_16x16x32_bf16 v[152:155], v[236:239], v[208:211], v[152:155]
    v_mfma_f32_16x16x32_bf16 v[156:159], v[236:239], v[212:215], v[156:159]
    s_waitcnt lgkmcnt(0)
    v_mfma_f32_16x16x32_bf16 v[96:99], v[184:187], v[160:163], v[96:99]
    v_cos_f32 v20, v47
    v_sin_f32 v21, v47
    v_mul_f32 v20, v20, v46
    ds_read_b128 v[200:203], v51 offset:0
    v_mfma_f32_16x16x32_bf16 v[100:103], v[184:187], v[164:167], v[100:103]
    v_mul_f32 v21, v21, v46
    v_mul_f32 v46, s85, v44
    v_mul_f32 v47, s85, v45
    ds_read_b128 v[204:207], v51 offset:2048
    v_mfma_f32_16x16x32_bf16 v[104:107], v[184:187], v[168:171], v[104:107]
    v_exp_f32 v46, v46
    v_fract_f32 v47, v47
    v_cos_f32 v24, v47
    ds_read_b128 v[208:211], v51 offset:4096
    v_mfma_f32_16x16x32_bf16 v[108:111], v[184:187], v[172:175], v[108:111]
    v_sin_f32 v25, v47
    v_mul_f32 v24, v24, v46
    v_mul_f32 v25, v25, v46
    ds_read_b128 v[212:215], v51 offset:6144
    v_mfma_f32_16x16x32_bf16 v[112:115], v[188:191], v[160:163], v[112:115]
    v_mul_f32 v46, v27, v27
    v_fmac_f32 v46, v28, v28
    v_rcp_f32 v46, v46
    ds_read_b64_tr_b16 v[224:225], v54 offset:7168
    v_mfma_f32_16x16x32_bf16 v[116:119], v[188:191], v[164:167], v[116:119]
    v_add_f32 v47, -1.0, v14
    v_mul_f32 v22, v47, v27
    v_fmac_f32 v22, v15, v28
    ds_read_b64_tr_b16 v[226:227], v54 offset:8960
    v_mfma_f32_16x16x32_bf16 v[120:123], v[188:191], v[168:171], v[120:123]
    v_mul_f32 v23, v15, v27
    v_fma_f32 v23, -v47, v28, v23
    v_add_f32 v46, v46, v46
    ds_read_b64_tr_b16 v[228:229], v54 offset:7200
    v_mfma_f32_16x16x32_bf16 v[124:127], v[188:191], v[172:175], v[124:127]
    v_mul_f32 v22, v22, v46
    v_mul_f32 v23, v23, v46
    v_mov_b32 v40, 0
    ds_read_b64_tr_b16 v[230:231], v54 offset:8992
    v_mfma_f32_16x16x32_bf16 v[128:131], v[192:195], v[160:163], v[128:131]
    v_mov_b32 v41, 0
    v_lshlrev_b32 v42, 16, v240
    v_and_b32 v43, 0xffff0000, v240
    ds_read_b64_tr_b16 v[232:233], v54 offset:7232
    v_mfma_f32_16x16x32_bf16 v[132:135], v[192:195], v[164:167], v[132:135]
    v_lshlrev_b32 v44, 16, v248
    v_and_b32 v45, 0xffff0000, v248
    v_mul_f32 v42, v42, v44
    ds_read_b64_tr_b16 v[234:235], v54 offset:9024
    v_mfma_f32_16x16x32_bf16 v[136:139], v[192:195], v[168:171], v[136:139]
    v_mul_f32 v43, v43, v45
    v_cvt_pk_bf16_f32 v42, v42, v43
    v_lshlrev_b32 v43, 16, v42
    ds_read_b64_tr_b16 v[236:237], v54 offset:7264
    v_mfma_f32_16x16x32_bf16 v[140:143], v[192:195], v[172:175], v[140:143]
    v_and_b32 v42, 0xffff0000, v42
    ds_read_b64_tr_b16 v[238:239], v54 offset:9056
    v_mfma_f32_16x16x32_bf16 v[144:147], v[196:199], v[160:163], v[144:147]
    v_mfma_f32_16x16x32_bf16 v[148:151], v[196:199], v[164:167], v[148:151]
    v_mfma_f32_16x16x32_bf16 v[152:155], v[196:199], v[168:171], v[152:155]
    v_mfma_f32_16x16x32_bf16 v[156:159], v[196:199], v[172:175], v[156:159]
    s_waitcnt vmcnt(0) lgkmcnt(0)
    s_barrier
    s_mov_b32 s93, s96
    s_mov_b32 s96, s95
    v_add_u32 v50, s95, v8
    v_xor_b32 v52, 0x2000, v52
    v_add_u32 v54, s95, v12
    v_add_u32 v55, s95, v13
    v_mfma_f32_16x16x32_bf16 v[96:99], v[224:227], v[200:203], v[96:99]
    v_add_f32 v40, v40, v43
    v_add_f32 v41, v41, v42
    v_lshlrev_b32 v42, 16, v241
    ds_read_b128 v[160:163], v50 offset:0
    v_add_u32 v51, s95, v9
    v_xor_b32 v53, 0x2000, v53
    v_mfma_f32_16x16x32_bf16 v[100:103], v[224:227], v[204:207], v[100:103]
    v_and_b32 v43, 0xffff0000, v241
    v_lshlrev_b32 v44, 16, v249
    v_and_b32 v45, 0xffff0000, v249
    ds_read_b128 v[164:167], v50 offset:2048
    s_add_u32 s95, s95, 47104
    s_cmp_lt_u32 s95, 141312
    s_cselect_b32 s95, s95, 0
    v_mfma_f32_16x16x32_bf16 v[104:107], v[224:227], v[208:211], v[104:107]
    v_mul_f32 v42, v42, v44
    v_mul_f32 v43, v43, v45
    v_cvt_pk_bf16_f32 v42, v42, v43
    ds_read_b128 v[168:171], v50 offset:4096
    s_mov_b32 s28, s60
    s_mov_b32 s29, s61
    s_mov_b32 s30, 256
    s_mov_b32 s31, 0x00020000
    v_mov_b32 v33, 0
    v_mfma_f32_16x16x32_bf16 v[108:111], v[224:227], v[212:215], v[108:111]
    v_lshlrev_b32 v43, 16, v42
    v_and_b32 v42, 0xffff0000, v42
    v_add_f32 v40, v40, v43
    ds_read_b128 v[172:175], v50 offset:6144
    v_mfma_f32_16x16x32_bf16 v[112:115], v[228:231], v[200:203], v[112:115]
    v_add_f32 v41, v41, v42
    v_lshlrev_b32 v42, 16, v242
    v_and_b32 v43, 0xffff0000, v242
    buffer_load_dword v48, v33, s[28:31], 0 offen sc1
    v_mfma_f32_16x16x32_bf16 v[116:119], v[228:231], v[204:207], v[116:119]
    v_lshlrev_b32 v44, 16, v250
    v_and_b32 v45, 0xffff0000, v250
    v_mul_f32 v42, v42, v44
    ds_read_b64_tr_b16 v[184:185], v54 offset:0
    v_mfma_f32_16x16x32_bf16 v[120:123], v[228:231], v[208:211], v[120:123]
    v_mul_f32 v43, v43, v45
    v_cvt_pk_bf16_f32 v42, v42, v43
    v_lshlrev_b32 v43, 16, v42
    ds_read_b64_tr_b16 v[186:187], v54 offset:1792
    v_mfma_f32_16x16x32_bf16 v[124:127], v[228:231], v[212:215], v[124:127]
    v_and_b32 v42, 0xffff0000, v42
    v_add_f32 v40, v40, v43
    v_add_f32 v41, v41, v42
    ds_read_b64_tr_b16 v[188:189], v54 offset:32
    v_mfma_f32_16x16x32_bf16 v[128:131], v[232:235], v[200:203], v[128:131]
    v_lshlrev_b32 v42, 16, v243
    v_and_b32 v43, 0xffff0000, v243
    v_lshlrev_b32 v44, 16, v251
    ds_read_b64_tr_b16 v[190:191], v54 offset:1824
    v_mfma_f32_16x16x32_bf16 v[132:135], v[232:235], v[204:207], v[132:135]
    v_and_b32 v45, 0xffff0000, v251
    v_mul_f32 v42, v42, v44
    v_mul_f32 v43, v43, v45
    ds_read_b64_tr_b16 v[192:193], v54 offset:64
    v_mfma_f32_16x16x32_bf16 v[136:139], v[232:235], v[208:211], v[136:139]
    v_cvt_pk_bf16_f32 v42, v42, v43
    v_lshlrev_b32 v43, 16, v42
    v_and_b32 v42, 0xffff0000, v42
    ds_read_b64_tr_b16 v[194:195], v54 offset:1856
    v_mfma_f32_16x16x32_bf16 v[140:143], v[232:235], v[212:215], v[140:143]
    v_add_f32 v40, v40, v43
    ds_read_b64_tr_b16 v[196:197], v54 offset:96
    v_mfma_f32_16x16x32_bf16 v[144:147], v[236:239], v[200:203], v[144:147]
    ds_read_b64_tr_b16 v[198:199], v54 offset:1888
    v_mfma_f32_16x16x32_bf16 v[148:151], v[236:239], v[204:207], v[148:151]
    v_mfma_f32_16x16x32_bf16 v[152:155], v[236:239], v[208:211], v[152:155]
    v_mfma_f32_16x16x32_bf16 v[156:159], v[236:239], v[212:215], v[156:159]
    s_waitcnt lgkmcnt(0)
    v_mfma_f32_16x16x32_bf16 v[96:99], v[184:187], v[160:163], v[96:99]
    v_add_f32 v41, v41, v42
    v_lshlrev_b32 v42, 16, v244
    v_and_b32 v43, 0xffff0000, v244
    ds_read_b128 v[200:203], v51 offset:0
    v_mfma_f32_16x16x32_bf16 v[100:103], v[184:187], v[164:167], v[100:103]
    v_lshlrev_b32 v44, 16, v252
    v_and_b32 v45, 0xffff0000, v252
    v_mul_f32 v42, v42, v44
    ds_read_b128 v[204:207], v51 offset:2048
    v_mfma_f32_16x16x32_bf16 v[104:107], v[184:187], v[168:171], v[104:107]
    v_mul_f32 v43, v43, v45
    v_cvt_pk_bf16_f32 v42, v42, v43
    v_lshlrev_b32 v43, 16, v42
    ds_read_b128 v[208:211], v51 offset:4096
    v_mfma_f32_16x16x32_bf16 v[108:111], v[184:187], v[172:175], v[108:111]
    v_and_b32 v42, 0xffff0000, v42
    v_add_f32 v40, v40, v43
    v_add_f32 v41, v41, v42
    ds_read_b128 v[212:215], v51 offset:6144
    v_mfma_f32_16x16x32_bf16 v[112:115], v[188:191], v[160:163], v[112:115]
    v_lshlrev_b32 v42, 16, v245
    v_and_b32 v43, 0xffff0000, v245
    v_lshlrev_b32 v44, 16, v253
    ds_read_b64_tr_b16 v[224:225], v54 offset:7168
    v_mfma_f32_16x16x32_bf16 v[116:119], v[188:191], v[164:167], v[116:119]
    v_and_b32 v45, 0xffff0000, v253
    v_mul_f32 v42, v42, v44
    v_mul_f32 v43, v43, v45
    ds_read_b64_tr_b16 v[226:227], v54 offset:8960
    v_mfma_f32_16x16x32_bf16 v[120:123], v[188:191], v[168:171], v[120:123]
    v_cvt_pk_bf16_f32 v42, v42, v43
    v_lshlrev_b32 v43, 16, v42
    v_and_b32 v42, 0xffff0000, v42
    ds_read_b64_tr_b16 v[228:229], v54 offset:7200
    v_mfma_f32_16x16x32_bf16 v[124:127], v[188:191], v[172:175], v[124:127]
    v_add_f32 v40, v40, v43
    v_add_f32 v41, v41, v42
    v_lshlrev_b32 v42, 16, v246
    ds_read_b64_tr_b16 v[230:231], v54 offset:8992
    v_mfma_f32_16x16x32_bf16 v[128:131], v[192:195], v[160:163], v[128:131]
    v_and_b32 v43, 0xffff0000, v246
    v_lshlrev_b32 v44, 16, v254
    v_and_b32 v45, 0xffff0000, v254
    ds_read_b64_tr_b16 v[232:233], v54 offset:7232
    v_mfma_f32_16x16x32_bf16 v[132:135], v[192:195], v[164:167], v[132:135]
    v_mul_f32 v42, v42, v44
    v_mul_f32 v43, v43, v45
    v_cvt_pk_bf16_f32 v42, v42, v43
    ds_read_b64_tr_b16 v[234:235], v54 offset:9024
    v_mfma_f32_16x16x32_bf16 v[136:139], v[192:195], v[168:171], v[136:139]
    v_lshlrev_b32 v43, 16, v42
    v_and_b32 v42, 0xffff0000, v42
    v_add_f32 v40, v40, v43
    ds_read_b64_tr_b16 v[236:237], v54 offset:7264
    v_mfma_f32_16x16x32_bf16 v[140:143], v[192:195], v[172:175], v[140:143]
    ds_read_b64_tr_b16 v[238:239], v54 offset:9056
    s_mul_i32 s80, s68, 112
    s_add_u32 s81, s80, s89
    s_lshr_b32 s81, s81, 5
    s_add_u32 s82, s80, s91
    s_lshr_b32 s82, s82, 5
    s_mul_i32 s83, s67, 88
    s_add_u32 s83, s83, 32
    s_lshl_b32 s83, s83, 15
    s_lshl_b32 s84, s65, 13
    s_add_u32 s83, s83, s84
    v_lshlrev_b32 v1, 4, v0
    v_add_u32 v2, 4096, v1
    s_lshl_b32 s84, s88, 3
    v_add_u32 v3, s84, v1
    v_add_u32 v4, s84, v2
    v_add_u32 v5, 94208, v8
    v_add_u32 v6, 94208, v9
    v_mfma_f32_16x16x32_bf16 v[144:147], v[196:199], v[160:163], v[144:147]
    v_mfma_f32_16x16x32_bf16 v[148:151], v[196:199], v[164:167], v[148:151]
    v_mfma_f32_16x16x32_bf16 v[152:155], v[196:199], v[168:171], v[152:155]
    v_mfma_f32_16x16x32_bf16 v[156:159], v[196:199], v[172:175], v[156:159]
    s_waitcnt lgkmcnt(0)
    v_mfma_f32_16x16x32_bf16 v[96:99], v[224:227], v[200:203], v[96:99]
    v_add_f32 v41, v41, v42
    v_lshlrev_b32 v42, 16, v247
    v_and_b32 v43, 0xffff0000, v247
    ds_read_b128 v[160:163], v5 offset:0
    v_mfma_f32_16x16x32_bf16 v[100:103], v[224:227], v[204:207], v[100:103]
    v_lshlrev_b32 v44, 16, v255
    v_and_b32 v45, 0xffff0000, v255
    v_mul_f32 v42, v42, v44
    ds_read_b128 v[176:179], v10 offset:0
    v_mfma_f32_16x16x32_bf16 v[104:107], v[224:227], v[208:211], v[104:107]
    v_mul_f32 v43, v43, v45
    v_cvt_pk_bf16_f32 v42, v42, v43
    v_lshlrev_b32 v43, 16, v42
    ds_read_b128 v[164:167], v5 offset:2048
    v_mfma_f32_16x16x32_bf16 v[108:111], v[224:227], v[212:215], v[108:111]
    v_and_b32 v42, 0xffff0000, v42
    v_add_f32 v40, v40, v43
    v_add_f32 v41, v41, v42
    ds_read_b128 v[168:171], v5 offset:4096
    v_mfma_f32_16x16x32_bf16 v[112:115], v[228:231], v[200:203], v[112:115]
    v_add_f32 v40, v40, v41
    s_nop 1
    v_add_f32_dpp v40, v40, v40 row_shr:1 row_mask:0xf bank_mask:0xf
    s_nop 1
    v_add_f32_dpp v40, v40, v40 row_shr:2 row_mask:0xf bank_mask:0xf
    ds_read_b128 v[172:175], v5 offset:6144
    v_mfma_f32_16x16x32_bf16 v[116:119], v[228:231], v[204:207], v[116:119]
    v_add_f32_dpp v40, v40, v40 row_shr:4 row_mask:0xf bank_mask:0xf
    s_nop 1
    v_add_f32_dpp v40, v40, v40 row_shr:8 row_mask:0xf bank_mask:0xf
    s_nop 1
    v_add_f32_dpp v40, v40, v40 row_bcast:15 row_mask:0xa bank_mask:0xf
    ds_read_b128 v[180:183], v10 offset:2048
    v_mfma_f32_16x16x32_bf16 v[120:123], v[228:231], v[208:211], v[120:123]
    v_add_f32_dpp v40, v40, v40 row_bcast:31 row_mask:0xc bank_mask:0xf
    s_nop 0
    v_readlane_b32 s85, v40, 63
    s_nop 1
    v_mov_b32 v40, s85
    v_mfma_f32_16x16x32_bf16 v[124:127], v[228:231], v[212:215], v[124:127]
    v_cvt_pk_bf16_f32 v40, v40, v40
    v_lshlrev_b32 v40, 16, v40
    v_mul_f32 v40, 3216550459, v40
    v_mfma_f32_16x16x32_bf16 v[128:131], v[232:235], v[200:203], v[128:131]
    v_exp_f32 v40, v40
    s_nop 0
    v_add_f32 v40, 1.0, v40
    v_rcp_f32 v40, v40
    v_mfma_f32_16x16x32_bf16 v[132:135], v[232:235], v[204:207], v[132:135]
    v_cvt_pk_bf16_f32 v40, v40, v40
    v_lshlrev_b32 v40, 16, v40
    s_lshl_b32 s85, s87, 2
    v_mfma_f32_16x16x32_bf16 v[136:139], v[232:235], v[208:211], v[136:139]
    s_add_u32 s85, s85, 23068672
    v_mov_b32 v41, 0
    buffer_store_dword v40, v41, s[16:19], s85 offen sc1
    v_mfma_f32_16x16x32_bf16 v[140:143], v[232:235], v[212:215], v[140:143]
    v_mfma_f32_16x16x32_bf16 v[144:147], v[236:239], v[200:203], v[144:147]
    v_mfma_f32_16x16x32_bf16 v[148:151], v[236:239], v[204:207], v[148:151]
    v_mfma_f32_16x16x32_bf16 v[152:155], v[236:239], v[208:211], v[152:155]
    v_mfma_f32_16x16x32_bf16 v[156:159], v[236:239], v[212:215], v[156:159]
    s_add_u32 s20, s62, 23134208
    s_addc_u32 s21, s63, 0
    s_mov_b32 s22, 131072
    s_mov_b32 s23, 0x00020000
    s_lshr_b32 s69, s68, 3
    s_and_b32 s78, s68, 7
    v_and_b32 v32, 15, v0
    s_sub_u32 s80, s67, 7
    s_lshl_b32 s80, s80, 14
    s_lshl_b32 s84, s68, 9
    s_add_u32 s80, s80, s84
    s_add_u32 s80, s80, 0
    v_lshlrev_b32 v27, 4, v32
    v_lshrrev_b32 v44, 4, v0
    v_lshl_add_u32 v27, v44, 14, v27
    v_add_u32 v27, s80, v27
    v_add_u32 v252, 0x10000, v27
    v_mov_b32 v45, 0x80000000
    v_cmp_eq_u32 vcc, 3, v44
    s_nop 1
    v_cndmask_b32 v252, v252, v45, vcc
    v_cmp_gt_u32 vcc, 0x20000, v27
    s_nop 1
    v_cndmask_b32 v253, 0, -1, vcc
    v_cmp_gt_u32 vcc, 0x20000, v252
    s_nop 1
    v_cndmask_b32 v254, 0, -1, vcc
    s_lshl_b32 s80, s67, 5
    s_lshl_b32 s84, s69, 3
    s_add_u32 s80, s80, s84
    s_lshl_b32 s80, s80, 7
    s_add_u32 s70, s80, 23658496
    v_and_b32 v30, 7, v0
    s_cmp_lt_u32 s78, 2
    s_cselect_b32 s84, 8, s78
    v_cmp_ne_u32 vcc, s84, v30
    s_nop 1
    v_cndmask_b32 v43, 0, -1, vcc
    v_lshlrev_b32 v30, 7, v30
    buffer_load_dwordx4 v[240:243], v27, s[20:23], 0 offen sc1
    buffer_load_dwordx4 v[244:247], v252, s[20:23], 0 offen sc1
    buffer_load_dword v31, v30, s[16:19], s70 offen sc1
    s_waitcnt lgkmcnt(0)
    v_mfma_f32_16x16x32_bf16 v[64:67], v[160:163], v[176:179], v[64:67]
    ds_read_b128 v[200:203], v6 offset:0
    v_mfma_f32_16x16x32_bf16 v[68:71], v[164:167], v[176:179], v[68:71]
    ds_read_b128 v[216:219], v11 offset:0
    v_mfma_f32_16x16x32_bf16 v[72:75], v[168:171], v[176:179], v[72:75]
    ds_read_b128 v[204:207], v6 offset:2048
    s_lshr_b32 s71, s81, 1
    s_lshl_b32 s71, s71, 15
    s_and_b32 s72, s81, 1
    s_lshl_b32 s72, s72, 10
    s_add_u32 s71, s71, s72
    s_add_u32 s92, s71, s83
    s_add_u32 s81, s81, 1
    v_cvt_pk_bf16_f32 v184, v96, v97
    v_cvt_pk_bf16_f32 v185, v98, v99
    v_cvt_pk_bf16_f32 v186, v112, v113
    v_cvt_pk_bf16_f32 v187, v114, v115
    v_pk_max_i16 v184, v184, 0
    v_pk_max_i16 v185, v185, 0
    v_pk_max_i16 v186, v186, 0
    v_pk_max_i16 v187, v187, 0
    buffer_store_dwordx4 v[184:187], v1, s[16:19], s92 offen offset:0 sc1
    v_mfma_f32_16x16x32_bf16 v[76:79], v[172:175], v[176:179], v[76:79]
    ds_read_b128 v[208:211], v6 offset:4096
    v_mfma_f32_16x16x32_bf16 v[80:83], v[160:163], v[180:183], v[80:83]
    ds_read_b128 v[212:215], v6 offset:6144
    v_mfma_f32_16x16x32_bf16 v[84:87], v[164:167], v[180:183], v[84:87]
    ds_read_b128 v[220:223], v11 offset:2048
    v_mfma_f32_16x16x32_bf16 v[88:91], v[168:171], v[180:183], v[88:91]
    v_cvt_pk_bf16_f32 v188, v100, v101
    v_cvt_pk_bf16_f32 v189, v102, v103
    v_cvt_pk_bf16_f32 v190, v116, v117
    v_cvt_pk_bf16_f32 v191, v118, v119
    v_pk_max_i16 v188, v188, 0
    v_pk_max_i16 v189, v189, 0
    v_pk_max_i16 v190, v190, 0
    v_pk_max_i16 v191, v191, 0
    buffer_store_dwordx4 v[188:191], v1, s[16:19], s92 offen offset:2048 sc1
    v_mfma_f32_16x16x32_bf16 v[92:95], v[172:175], v[180:183], v[92:95]
    s_waitcnt lgkmcnt(0)
    v_mfma_f32_16x16x32_bf16 v[64:67], v[200:203], v[216:219], v[64:67]
    ds_read_b128 v[160:163], v50 offset:0
    v_mfma_f32_16x16x32_bf16 v[68:71], v[204:207], v[216:219], v[68:71]
    ds_read_b128 v[176:179], v52 offset:0
    v_mfma_f32_16x16x32_bf16 v[72:75], v[208:211], v[216:219], v[72:75]
    ds_read_b128 v[164:167], v50 offset:2048
    v_cvt_pk_bf16_f32 v192, v104, v105
    v_cvt_pk_bf16_f32 v193, v106, v107
    v_cvt_pk_bf16_f32 v194, v120, v121
    v_cvt_pk_bf16_f32 v195, v122, v123
    v_pk_max_i16 v192, v192, 0
    v_pk_max_i16 v193, v193, 0
    v_pk_max_i16 v194, v194, 0
    v_pk_max_i16 v195, v195, 0
    buffer_store_dwordx4 v[192:195], v2, s[16:19], s92 offen offset:0 sc1
    v_mfma_f32_16x16x32_bf16 v[76:79], v[212:215], v[216:219], v[76:79]
    ds_read_b128 v[168:171], v50 offset:4096
    v_mfma_f32_16x16x32_bf16 v[80:83], v[200:203], v[220:223], v[80:83]
    ds_read_b128 v[172:175], v50 offset:6144
    v_mfma_f32_16x16x32_bf16 v[84:87], v[204:207], v[220:223], v[84:87]
    ds_read_b128 v[180:183], v52 offset:2048
    v_mfma_f32_16x16x32_bf16 v[88:91], v[208:211], v[220:223], v[88:91]
    v_cvt_pk_bf16_f32 v196, v108, v109
    v_cvt_pk_bf16_f32 v197, v110, v111
    v_cvt_pk_bf16_f32 v198, v124, v125
    v_cvt_pk_bf16_f32 v199, v126, v127
    v_pk_max_i16 v196, v196, 0
    v_pk_max_i16 v197, v197, 0
    v_pk_max_i16 v198, v198, 0
    v_pk_max_i16 v199, v199, 0
    buffer_store_dwordx4 v[196:199], v2, s[16:19], s92 offen offset:2048 sc1
    v_mfma_f32_16x16x32_bf16 v[92:95], v[212:215], v[220:223], v[92:95]
    s_waitcnt lgkmcnt(0)
    v_mfma_f32_16x16x32_bf16 v[64:67], v[160:163], v[176:179], v[64:67]
    ds_read_b128 v[200:203], v51 offset:0
    v_mfma_f32_16x16x32_bf16 v[68:71], v[164:167], v[176:179], v[68:71]
    ds_read_b128 v[216:219], v53 offset:0
    v_mfma_f32_16x16x32_bf16 v[72:75], v[168:171], v[176:179], v[72:75]
    ds_read_b128 v[204:207], v51 offset:2048
    s_lshr_b32 s71, s81, 1
    s_lshl_b32 s71, s71, 15
    s_and_b32 s72, s81, 1
    s_lshl_b32 s72, s72, 10
    s_add_u32 s71, s71, s72
    s_add_u32 s92, s71, s83
    s_add_u32 s81, s81, 1
    v_cvt_pk_bf16_f32 v224, v128, v129
    v_cvt_pk_bf16_f32 v225, v130, v131
    v_cvt_pk_bf16_f32 v226, v144, v145
    v_cvt_pk_bf16_f32 v227, v146, v147
    v_pk_max_i16 v224, v224, 0
    v_pk_max_i16 v225, v225, 0
    v_pk_max_i16 v226, v226, 0
    v_pk_max_i16 v227, v227, 0
    buffer_store_dwordx4 v[224:227], v1, s[16:19], s92 offen offset:0 sc1
    v_mfma_f32_16x16x32_bf16 v[76:79], v[172:175], v[176:179], v[76:79]
    ds_read_b128 v[208:211], v51 offset:4096
    v_mfma_f32_16x16x32_bf16 v[80:83], v[160:163], v[180:183], v[80:83]
    ds_read_b128 v[212:215], v51 offset:6144
    v_mfma_f32_16x16x32_bf16 v[84:87], v[164:167], v[180:183], v[84:87]
    ds_read_b128 v[220:223], v53 offset:2048
    v_mfma_f32_16x16x32_bf16 v[88:91], v[168:171], v[180:183], v[88:91]
    v_cvt_pk_bf16_f32 v228, v132, v133
    v_cvt_pk_bf16_f32 v229, v134, v135
    v_cvt_pk_bf16_f32 v230, v148, v149
    v_cvt_pk_bf16_f32 v231, v150, v151
    v_pk_max_i16 v228, v228, 0
    v_pk_max_i16 v229, v229, 0
    v_pk_max_i16 v230, v230, 0
    v_pk_max_i16 v231, v231, 0
    buffer_store_dwordx4 v[228:231], v1, s[16:19], s92 offen offset:2048 sc1
    v_mfma_f32_16x16x32_bf16 v[92:95], v[172:175], v[180:183], v[92:95]
    s_waitcnt lgkmcnt(0)
    v_mfma_f32_16x16x32_bf16 v[64:67], v[200:203], v[216:219], v[64:67]
    v_mfma_f32_16x16x32_bf16 v[68:71], v[204:207], v[216:219], v[68:71]
    v_mfma_f32_16x16x32_bf16 v[72:75], v[208:211], v[216:219], v[72:75]
    v_cvt_pk_bf16_f32 v232, v136, v137
    v_cvt_pk_bf16_f32 v233, v138, v139
    v_cvt_pk_bf16_f32 v234, v152, v153
    v_cvt_pk_bf16_f32 v235, v154, v155
    v_pk_max_i16 v232, v232, 0
    v_pk_max_i16 v233, v233, 0
    v_pk_max_i16 v234, v234, 0
    v_pk_max_i16 v235, v235, 0
    buffer_store_dwordx4 v[232:235], v2, s[16:19], s92 offen offset:0 sc1
    v_mfma_f32_16x16x32_bf16 v[76:79], v[212:215], v[216:219], v[76:79]
    v_mfma_f32_16x16x32_bf16 v[80:83], v[200:203], v[220:223], v[80:83]
    v_mfma_f32_16x16x32_bf16 v[84:87], v[204:207], v[220:223], v[84:87]
    v_mfma_f32_16x16x32_bf16 v[88:91], v[208:211], v[220:223], v[88:91]
    v_cvt_pk_bf16_f32 v236, v140, v141
    v_cvt_pk_bf16_f32 v237, v142, v143
    v_cvt_pk_bf16_f32 v238, v156, v157
    v_cvt_pk_bf16_f32 v239, v158, v159
    v_pk_max_i16 v236, v236, 0
    v_pk_max_i16 v237, v237, 0
    v_pk_max_i16 v238, v238, 0
    v_pk_max_i16 v239, v239, 0
    buffer_store_dwordx4 v[236:239], v2, s[16:19], s92 offen offset:2048 sc1
    v_mfma_f32_16x16x32_bf16 v[92:95], v[212:215], v[220:223], v[92:95]
    v_lshlrev_b32 v46, 3, v0
    s_lshl_b32 s84, s64, 9
    s_add_u32 s84, s84, 153600
    v_add_u32 v46, s84, v46
    v_mov_b32 v36, 0
    v_mov_b32 v37, 0
    ds_write_b64 v46, v[36:37]
    v_fmac_f32 v65, v14, v64
    v_fmac_f32 v81, v14, v80
    v_fma_f32 v65, -v15, v80, v65
    v_fmac_f32 v81, v15, v64
    v_fmac_f32 v66, v14, v65
    v_fmac_f32 v82, v14, v81
    v_fma_f32 v66, -v15, v81, v66
    v_fmac_f32 v82, v15, v65
    v_fmac_f32 v67, v14, v66
    v_fmac_f32 v83, v14, v82
    v_fma_f32 v67, -v15, v82, v67
    v_fmac_f32 v83, v15, v66
    v_fmac_f32 v68, v14, v67
    v_fmac_f32 v84, v14, v83
    v_fma_f32 v68, -v15, v83, v68
    v_fmac_f32 v84, v15, v67
    v_fmac_f32 v69, v14, v68
    v_fmac_f32 v85, v14, v84
    v_fma_f32 v69, -v15, v84, v69
    v_fmac_f32 v85, v15, v68
    v_fmac_f32 v70, v14, v69
    v_fmac_f32 v86, v14, v85
    v_fma_f32 v70, -v15, v85, v70
    v_fmac_f32 v86, v15, v69
    v_fmac_f32 v71, v14, v70
    v_fmac_f32 v87, v14, v86
    v_fma_f32 v71, -v15, v86, v71
    v_fmac_f32 v87, v15, v70
    v_fmac_f32 v72, v14, v71
    v_fmac_f32 v88, v14, v87
    v_fma_f32 v72, -v15, v87, v72
    v_fmac_f32 v88, v15, v71
    v_fmac_f32 v73, v14, v72
    v_fmac_f32 v89, v14, v88
    v_fma_f32 v73, -v15, v88, v73
    v_fmac_f32 v89, v15, v72
    v_fmac_f32 v74, v14, v73
    v_fmac_f32 v90, v14, v89
    v_fma_f32 v74, -v15, v89, v74
    v_fmac_f32 v90, v15, v73
    v_fmac_f32 v75, v14, v74
    v_fmac_f32 v91, v14, v90
    v_fma_f32 v75, -v15, v90, v75
    v_fmac_f32 v91, v15, v74
    v_fmac_f32 v76, v14, v75
    v_fmac_f32 v92, v14, v91
    v_fma_f32 v76, -v15, v91, v76
    v_fmac_f32 v92, v15, v75
    v_fmac_f32 v77, v14, v76
    v_fmac_f32 v93, v14, v92
    v_fma_f32 v77, -v15, v92, v77
    v_fmac_f32 v93, v15, v76
    v_fmac_f32 v78, v14, v77
    v_fmac_f32 v94, v14, v93
    v_fma_f32 v78, -v15, v93, v78
    v_fmac_f32 v94, v15, v77
    v_fmac_f32 v79, v14, v78
    v_fmac_f32 v95, v14, v94
    v_fma_f32 v79, -v15, v94, v79
    v_fmac_f32 v95, v15, v78
    v_lshlrev_b32 v46, 8, v26
    v_lshl_add_u32 v46, v32, 3, v46
    v_mov_b32 v36, v79
    v_mov_b32 v37, v95
    v_add_u32 v38, 153856, v46
    v_add_u32 v46, 157696, v46
    ds_write_b64 v46, v[36:37]
    s_waitcnt vmcnt(12)
k1_np0:
    v_readfirstlane_b32 s100, v48
    s_nop 0
    s_cmp_lg_u32 s100, 0
    s_cbranch_scc1 k1_nq0
    s_sleep 4
    buffer_load_dword v48, v33, s[28:31], 0 offen sc1
    s_waitcnt vmcnt(0)
    s_branch k1_np0
k1_nq0:
    s_waitcnt lgkmcnt(0)
    s_barrier
    s_cmp_lg_u32 s64, 0
    s_cbranch_scc1 k1_nopub
    v_and_b32 v47, 31, v0
    v_lshlrev_b32 v47, 3, v47
    v_add_u32 v46, 157696, v47
    ds_read_b64 v[160:161], v46 offset:0
    ds_read_b64 v[162:163], v46 offset:256
    ds_read_b64 v[164:165], v46 offset:512
    ds_read_b64 v[166:167], v46 offset:768
    ds_read_b64 v[168:169], v46 offset:1024
    ds_read_b64 v[170:171], v46 offset:1280
    ds_read_b64 v[172:173], v46 offset:1536
    ds_read_b64 v[174:175], v46 offset:1792
    ds_read_b64 v[176:177], v46 offset:2048
    ds_read_b64 v[178:179], v46 offset:2304
    ds_read_b64 v[180:181], v46 offset:2560
    ds_read_b64 v[182:183], v46 offset:2816
    ds_read_b64 v[184:185], v46 offset:3072
    ds_read_b64 v[186:187], v46 offset:3328
    ds_read_b64 v[188:189], v46 offset:3584
    ds_read_b64 v[190:191], v46 offset:3840
    v_lshlrev_b32 v47, 1, v47
    v_mov_b32 v192, s100
    v_mov_b32 v193, s100
    s_waitcnt lgkmcnt(0)
    v_fmac_f32 v162, v24, v160
    v_fmac_f32 v163, v24, v161
    v_fma_f32 v162, -v25, v161, v162
    v_fmac_f32 v163, v25, v160
    v_fmac_f32 v164, v24, v162
    v_fmac_f32 v165, v24, v163
    v_fma_f32 v164, -v25, v163, v164
    v_fmac_f32 v165, v25, v162
    v_fmac_f32 v166, v24, v164
    v_fmac_f32 v167, v24, v165
    v_fma_f32 v166, -v25, v165, v166
    v_fmac_f32 v167, v25, v164
    v_fmac_f32 v168, v24, v166
    v_fmac_f32 v169, v24, v167
    v_fma_f32 v168, -v25, v167, v168
    v_fmac_f32 v169, v25, v166
    v_fmac_f32 v170, v24, v168
    v_fmac_f32 v171, v24, v169
    v_fma_f32 v170, -v25, v169, v170
    v_fmac_f32 v171, v25, v168
    v_fmac_f32 v172, v24, v170
    v_fmac_f32 v173, v24, v171
    v_fma_f32 v172, -v25, v171, v172
    v_fmac_f32 v173, v25, v170
    v_fmac_f32 v174, v24, v172
    v_fmac_f32 v175, v24, v173
    v_fma_f32 v174, -v25, v173, v174
    v_fmac_f32 v175, v25, v172
    v_fmac_f32 v176, v24, v174
    v_fmac_f32 v177, v24, v175
    v_fma_f32 v176, -v25, v175, v176
    v_fmac_f32 v177, v25, v174
    v_fmac_f32 v178, v24, v176
    v_fmac_f32 v179, v24, v177
    v_fma_f32 v178, -v25, v177, v178
    v_fmac_f32 v179, v25, v176
    v_fmac_f32 v180, v24, v178
    v_fmac_f32 v181, v24, v179
    v_fma_f32 v180, -v25, v179, v180
    v_fmac_f32 v181, v25, v178
    v_fmac_f32 v182, v24, v180
    v_fmac_f32 v183, v24, v181
    v_fma_f32 v182, -v25, v181, v182
    v_fmac_f32 v183, v25, v180
    v_fmac_f32 v184, v24, v182
    v_fmac_f32 v185, v24, v183
    v_fma_f32 v184, -v25, v183, v184
    v_fmac_f32 v185, v25, v182
    v_fmac_f32 v186, v24, v184
    v_fmac_f32 v187, v24, v185
    v_fma_f32 v186, -v25, v185, v186
    v_fmac_f32 v187, v25, v184
    v_fmac_f32 v188, v24, v186
    v_fmac_f32 v189, v24, v187
    v_fma_f32 v188, -v25, v187, v188
    v_fmac_f32 v189, v25, v186
    v_fmac_f32 v190, v24, v188
    v_fmac_f32 v191, v24, v189
    v_fma_f32 v190, -v25, v189, v190
    v_fmac_f32 v191, v25, v188
    s_lshl_b32 s80, s67, 14
    s_lshl_b32 s81, s68, 9
    s_add_u32 s80, s80, s81
    s_mov_b64 exec, 0xffffffff
    buffer_store_dwordx4 v[190:193], v47, s[20:23], s80 offen sc1
    s_mov_b64 exec, -1
k1_nopub:
    ds_read_b64 v[160:161], v38 offset:0
    ds_read_b64 v[162:163], v38 offset:256
    ds_read_b64 v[164:165], v38 offset:512
    ds_read_b64 v[166:167], v38 offset:768
    ds_read_b64 v[168:169], v38 offset:1024
    ds_read_b64 v[170:171], v38 offset:1280
    ds_read_b64 v[172:173], v38 offset:1536
    ds_read_b64 v[174:175], v38 offset:1792
    ds_read_b64 v[176:177], v38 offset:2048
    ds_read_b64 v[178:179], v38 offset:2304
    ds_read_b64 v[180:181], v38 offset:2560
    ds_read_b64 v[182:183], v38 offset:2816
    ds_read_b64 v[184:185], v38 offset:3072
    ds_read_b64 v[186:187], v38 offset:3328
    ds_read_b64 v[188:189], v38 offset:3584
    v_mov_b32 v44, 161792
    v_mov_b32 v45, 1
    s_mov_b64 exec, 1
    s_cmp_eq_u32 s64, 0
    s_cbranch_scc1 k1_w1
    s_waitcnt vmcnt(0)
k1_w1:
    s_waitcnt vmcnt(1)
    ds_add_rtn_u32 v46, v44, v45
    s_lshl_b32 s80, s67, 5
    s_add_u32 s80, s80, s68
    s_lshl_b32 s101, s80, 7
    s_add_u32 s80, s101, 23658496
    v_mov_b32 v44, 0
    v_mov_b32 v45, s100
    s_waitcnt lgkmcnt(0)
    v_readfirstlane_b32 s81, v46
    s_nop 0
    s_cmp_lg_u32 s81, 7
    s_cbranch_scc1 k1_nosig0
    buffer_store_dword v45, v44, s[16:19], s80 offen sc1
k1_nosig0:
    s_mov_b64 exec, -1
    s_mul_i32 s71, s78, 112
    s_add_u32 s71, s71, 175
    s_lshr_b32 s71, s71, 6
    s_mov_b32 s71, 0
    s_cmp_eq_u32 s71, 14
    s_cselect_b32 s85, 0, s71
    s_add_u32 s86, s85, 1
    s_cmp_eq_u32 s86, 14
    s_cselect_b32 s86, 0, s86
    s_add_u32 s87, s86, 1
    s_cmp_eq_u32 s87, 14
    s_cselect_b32 s87, 0, s87
    s_add_u32 s71, s87, 1
    s_cmp_eq_u32 s71, 14
    s_cselect_b32 s71, 0, s71
    s_mul_i32 s79, s69, 1835008
    s_lshl_b32 s97, s69, 9
    s_sub_u32 s97, s97, 896
    v_lshrrev_b32 v7, 3, v0
    v_and_b32 v8, 7, v0
    v_and_b32 v9, 15, v0
    v_lshrrev_b32 v10, 4, v0
    s_lshl_b32 s80, s64, 3
    v_add_u32 v12, s80, v10
    v_lshlrev_b32 v12, 11, v12
    s_lshl_b32 s80, s78, 8
    v_add_u32 v12, s80, v12
    v_lshlrev_b32 v13, 1, v10
    v_xor_b32 v13, v13, v9
    v_lshl_add_u32 v3, v13, 4, v12
    v_xor_b32 v4, 128, v3
    v_add_u32 v4, 0x2000, v4
    s_lshl_b32 s93, s64, 12
    s_add_u32 s94, s93, 2048
    s_lshl_b32 s95, s64, 11
    s_add_u32 s95, s95, 32768
    s_add_u32 s96, s95, 1024
    s_mov_b32 s8, s54
    s_mov_b32 s9, s55
    s_mov_b32 s10, 7340032
    s_mov_b32 s11, 0x00020000
    s_mov_b32 s4, s62
    s_mov_b32 s5, s63
    s_mov_b32 s6, 23068672
    s_mov_b32 s7, 0x00020000
    s_lshl_b32 s74, s85, 17
    s_add_u32 m0, s95, 0
    s_add_u32 s74, s74, s79
    buffer_load_dwordx4 v3, s[8:11], s74 offen lds
    s_lshl_b32 s74, s85, 17
    s_add_u32 m0, s96, 0
    s_add_u32 s74, s74, s79
    buffer_load_dwordx4 v4, s[8:11], s74 offen lds
    s_lshl_b32 s74, s86, 17
    s_add_u32 m0, s95, 49152
    s_add_u32 s74, s74, s79
    buffer_load_dwordx4 v3, s[8:11], s74 offen lds
    s_lshl_b32 s74, s86, 17
    s_add_u32 m0, s96, 49152
    s_add_u32 s74, s74, s79
    buffer_load_dwordx4 v4, s[8:11], s74 offen lds
    s_lshl_b32 s74, s87, 17
    s_add_u32 m0, s95, 98304
    s_add_u32 s74, s74, s79
    buffer_load_dwordx4 v3, s[8:11], s74 offen lds
    s_lshl_b32 s74, s87, 17
    s_add_u32 m0, s96, 98304
    s_add_u32 s74, s74, s79
    buffer_load_dwordx4 v4, s[8:11], s74 offen lds
    v_lshlrev_b32 v11, 4, v0
    s_lshr_b32 s80, s64, 1
    s_lshl_b32 s80, s80, 2
    s_and_b32 s81, s64, 1
    s_lshl_b32 s81, s81, 1
    s_add_u32 s81, s81, s69
    s_and_b32 s82, s81, 3
    s_add_u32 s82, s82, s80
    s_lshl_b32 s82, s82, 11
    v_add_u32 v1, s82, v11
    s_add_u32 s81, s81, 1
    s_and_b32 s82, s81, 3
    s_add_u32 s82, s82, s80
    s_lshl_b32 s82, s82, 11
    v_add_u32 v2, s82, v11
    s_lshl_b32 s80, s78, 7
    s_lshl_b32 s81, s64, 4
    s_add_u32 s80, s80, s81
    v_add_u32 v12, s80, v7
    v_lshlrev_b32 v12, 11, v12
    v_lshrrev_b32 v13, 1, v7
    v_xor_b32 v13, v13, v8
    v_lshl_add_u32 v5, v13, 4, v12
    v_xor_b32 v6, 64, v5
    v_add_u32 v6, 0x4000, v6
    s_mul_i32 s73, s67, 88
    s_mul_i32 s80, s69, 14
    s_add_u32 s73, s73, s80
    s_add_u32 s73, s73, 32
    s_lshl_b32 s90, s73, 15
    s_mov_b32 s72, 3
    s_mov_b32 s75, 0
    s_mov_b32 s76, 49152
    v_xor_b32 v44, s100, v242
    v_xor_b32 v45, s100, v246
    v_and_b32 v44, v44, v253
    v_and_or_b32 v44, v45, v254, v44
    v_cmp_ne_u32 vcc, 0, v44
    s_nop 3
    s_cmp_eq_u64 vcc, 0
    s_cselect_b32 s77, 1, 0
    s_mov_b32 s82, 0
    v_xor_b32 v31, s100, v31
    v_and_b32 v31, v31, v43
    v_cmp_ne_u32 vcc, 0, v31
    s_nop 3
    s_cbranch_vccnz k1_slow0
    s_mov_b32 s82, 1
    s_lshl_b32 s73, s85, 15
    s_add_u32 s73, s73, s90
    s_add_u32 m0, s93, 0
    s_nop 0
    buffer_load_dwordx4 v1, s[4:7], s73 offen sc1 lds
    buffer_load_dwordx4 v1, s[4:7], s73 offen offset:1024 sc1 lds
    s_add_u32 m0, s94, 0
    s_nop 0
    buffer_load_dwordx4 v2, s[4:7], s73 offen sc1 lds
    buffer_load_dwordx4 v2, s[4:7], s73 offen offset:1024 sc1 lds
    s_lshl_b32 s73, s86, 15
    s_add_u32 s73, s73, s90
    s_add_u32 m0, s93, 49152
    s_nop 0
    buffer_load_dwordx4 v1, s[4:7], s73 offen sc1 lds
    buffer_load_dwordx4 v1, s[4:7], s73 offen offset:1024 sc1 lds
    s_add_u32 m0, s94, 49152
    s_nop 0
    buffer_load_dwordx4 v2, s[4:7], s73 offen sc1 lds
    buffer_load_dwordx4 v2, s[4:7], s73 offen offset:1024 sc1 lds
k1_slow0:
    s_cmp_eq_u32 s77, 1
    s_cbranch_scc1 k1_ag10
    buffer_load_dwordx4 v[240:243], v27, s[20:23], 0 offen sc1
    buffer_load_dwordx4 v[244:247], v252, s[20:23], 0 offen sc1
k1_ag10:
    v_fmac_f32 v162, v16, v160
    v_fmac_f32 v163, v16, v161
    v_fma_f32 v162, -v17, v161, v162
    v_fmac_f32 v163, v17, v160
    v_fmac_f32 v164, v16, v162
    v_fmac_f32 v165, v16, v163
    v_fma_f32 v164, -v17, v163, v164
    v_fmac_f32 v165, v17, v162
    v_fmac_f32 v166, v16, v164
    v_fmac_f32 v167, v16, v165
    v_fma_f32 v166, -v17, v165, v166
    v_fmac_f32 v167, v17, v164
    v_fmac_f32 v168, v16, v166
    v_fmac_f32 v169, v16, v167
    v_fma_f32 v168, -v17, v167, v168
    v_fmac_f32 v169, v17, v166
    v_fmac_f32 v170, v16, v168
    v_fmac_f32 v171, v16, v169
    v_fma_f32 v170, -v17, v169, v170
    v_fmac_f32 v171, v17, v168
    v_fmac_f32 v172, v16, v170
    v_fmac_f32 v173, v16, v171
    v_fma_f32 v172, -v17, v171, v172
    v_fmac_f32 v173, v17, v170
    v_fmac_f32 v174, v16, v172
    v_fmac_f32 v175, v16, v173
    v_fma_f32 v174, -v17, v173, v174
    v_fmac_f32 v175, v17, v172
    v_fmac_f32 v176, v16, v174
    v_fmac_f32 v177, v16, v175
    v_fma_f32 v176, -v17, v175, v176
    v_fmac_f32 v177, v17, v174
    v_fmac_f32 v178, v16, v176
    v_fmac_f32 v179, v16, v177
    v_fma_f32 v178, -v17, v177, v178
    v_fmac_f32 v179, v17, v176
    v_fmac_f32 v180, v16, v178
    v_fmac_f32 v181, v16, v179
    v_fma_f32 v180, -v17, v179, v180
    v_fmac_f32 v181, v17, v178
    v_fmac_f32 v182, v16, v180
    v_fmac_f32 v183, v16, v181
    v_fma_f32 v182, -v17, v181, v182
    v_fmac_f32 v183, v17, v180
    v_fmac_f32 v184, v16, v182
    v_fmac_f32 v185, v16, v183
    v_fma_f32 v184, -v17, v183, v184
    v_fmac_f32 v185, v17, v182
    v_fmac_f32 v186, v16, v184
    v_fmac_f32 v187, v16, v185
    v_fma_f32 v186, -v17, v185, v186
    v_fmac_f32 v187, v17, v184
    v_fmac_f32 v188, v16, v186
    v_fmac_f32 v189, v16, v187
    v_fma_f32 v188, -v17, v187, v188
    v_fmac_f32 v189, v17, v186
    v_mov_b32 v28, v188
    v_mov_b32 v29, v189
    v_mul_f32 v44, v22, v64
    v_mul_f32 v45, v23, v64
    v_fma_f32 v64, -v23, v80, v44
    v_fma_f32 v80, -v22, v80, -v45
    v_mul_f32 v44, v22, v65
    v_mul_f32 v45, v23, v65
    v_fma_f32 v65, -v23, v81, v44
    v_fma_f32 v81, -v22, v81, -v45
    v_mul_f32 v44, v22, v66
    v_mul_f32 v45, v23, v66
    v_fma_f32 v66, -v23, v82, v44
    v_fma_f32 v82, -v22, v82, -v45
    v_mul_f32 v44, v22, v67
    v_mul_f32 v45, v23, v67
    v_fma_f32 v67, -v23, v83, v44
    v_fma_f32 v83, -v22, v83, -v45
    v_mul_f32 v44, v22, v68
    v_mul_f32 v45, v23, v68
    v_fma_f32 v68, -v23, v84, v44
    v_fma_f32 v84, -v22, v84, -v45
    v_mul_f32 v44, v22, v69
    v_mul_f32 v45, v23, v69
    v_fma_f32 v69, -v23, v85, v44
    v_fma_f32 v85, -v22, v85, -v45
    v_mul_f32 v44, v22, v70
    v_mul_f32 v45, v23, v70
    v_fma_f32 v70, -v23, v86, v44
    v_fma_f32 v86, -v22, v86, -v45
    v_mul_f32 v44, v22, v71
    v_mul_f32 v45, v23, v71
    v_fma_f32 v71, -v23, v87, v44
    v_fma_f32 v87, -v22, v87, -v45
    v_mul_f32 v44, v22, v72
    v_mul_f32 v45, v23, v72
    v_fma_f32 v72, -v23, v88, v44
    v_fma_f32 v88, -v22, v88, -v45
    v_mul_f32 v44, v22, v73
    v_mul_f32 v45, v23, v73
    v_fma_f32 v73, -v23, v89, v44
    v_fma_f32 v89, -v22, v89, -v45
    v_mul_f32 v44, v22, v74
    v_mul_f32 v45, v23, v74
    v_fma_f32 v74, -v23, v90, v44
    v_fma_f32 v90, -v22, v90, -v45
    v_mul_f32 v44, v22, v75
    v_mul_f32 v45, v23, v75
    v_fma_f32 v75, -v23, v91, v44
    v_fma_f32 v91, -v22, v91, -v45
    v_mul_f32 v44, v22, v76
    v_mul_f32 v45, v23, v76
    v_fma_f32 v76, -v23, v92, v44
    v_fma_f32 v92, -v22, v92, -v45
    v_mul_f32 v44, v22, v77
    v_mul_f32 v45, v23, v77
    v_fma_f32 v77, -v23, v93, v44
    v_fma_f32 v93, -v22, v93, -v45
    v_mul_f32 v44, v22, v78
    v_mul_f32 v45, v23, v78
    v_fma_f32 v78, -v23, v94, v44
    v_fma_f32 v94, -v22, v94, -v45
    v_mul_f32 v44, v22, v79
    v_mul_f32 v45, v23, v79
    v_fma_f32 v79, -v23, v95, v44
    v_fma_f32 v95, -v22, v95, -v45
    s_cmp_eq_u32 s82, 1
    s_cbranch_scc1 k1_hf10
    buffer_load_dword v31, v30, s[16:19], s70 offen sc1
k1_hf10:
    v_mov_b32 v160, v14
    v_mov_b32 v161, v15
    v_mul_f32 v162, v14, v160
    v_mul_f32 v163, v14, v161
    v_fma_f32 v162, -v15, v161, v162
    v_fmac_f32 v163, v15, v160
    v_mul_f32 v164, v14, v162
    v_mul_f32 v165, v14, v163
    v_fma_f32 v164, -v15, v163, v164
    v_fmac_f32 v165, v15, v162
    v_mul_f32 v166, v14, v164
    v_mul_f32 v167, v14, v165
    v_fma_f32 v166, -v15, v165, v166
    v_fmac_f32 v167, v15, v164
    v_mul_f32 v168, v14, v166
    v_mul_f32 v169, v14, v167
    v_fma_f32 v168, -v15, v167, v168
    v_fmac_f32 v169, v15, v166
    v_mul_f32 v170, v14, v168
    v_mul_f32 v171, v14, v169
    v_fma_f32 v170, -v15, v169, v170
    v_fmac_f32 v171, v15, v168
    v_mul_f32 v172, v14, v170
    v_mul_f32 v173, v14, v171
    v_fma_f32 v172, -v15, v171, v172
    v_fmac_f32 v173, v15, v170
    v_mul_f32 v174, v14, v172
    v_mul_f32 v175, v14, v173
    v_fma_f32 v174, -v15, v173, v174
    v_fmac_f32 v175, v15, v172
    v_mul_f32 v176, v14, v174
    v_mul_f32 v177, v14, v175
    v_fma_f32 v176, -v15, v175, v176
    v_fmac_f32 v177, v15, v174
    v_mul_f32 v178, v14, v176
    v_mul_f32 v179, v14, v177
    v_fma_f32 v178, -v15, v177, v178
    v_fmac_f32 v179, v15, v176
    v_mul_f32 v180, v14, v178
    v_mul_f32 v181, v14, v179
    v_fma_f32 v180, -v15, v179, v180
    v_fmac_f32 v181, v15, v178
    v_mul_f32 v182, v14, v180
    v_mul_f32 v183, v14, v181
    v_fma_f32 v182, -v15, v181, v182
    v_fmac_f32 v183, v15, v180
    v_mul_f32 v184, v14, v182
    v_mul_f32 v185, v14, v183
    v_fma_f32 v184, -v15, v183, v184
    v_fmac_f32 v185, v15, v182
    v_mul_f32 v186, v14, v184
    v_mul_f32 v187, v14, v185
    v_fma_f32 v186, -v15, v185, v186
    v_fmac_f32 v187, v15, v184
    v_mul_f32 v188, v14, v186
    v_mul_f32 v189, v14, v187
    v_fma_f32 v188, -v15, v187, v188
    v_fmac_f32 v189, v15, v186
    v_mul_f32 v190, v14, v188
    v_mul_f32 v191, v14, v189
    v_fma_f32 v190, -v15, v189, v190
    v_fmac_f32 v191, v15, v188
    v_and_b32 v50, 15, v0
    v_lshrrev_b32 v51, 4, v0
    v_lshlrev_b32 v52, 4, v0
    v_bfe_u32 v53, v0, 2, 2
    v_and_b32 v54, 3, v0
    v_lshl_add_u32 v55, v51, 3, v53
    v_and_b32 v46, 1, v54
    v_lshlrev_b32 v46, 2, v46
    v_lshrrev_b32 v47, 1, v54
    v_lshl_or_b32 v46, v47, 4, v46
    v_xor_b32 v55, v55, v46
    v_lshl_add_u32 v55, v54, 5, v55
    v_lshlrev_b32 v55, 3, v55
    s_lshl_b32 s80, s65, 13
    v_add_u32 v7, s80, v55
    v_xor_b32 v8, 32, v7
    v_add_u32 v11, s80, v52
    v_lshrrev_b32 v55, 1, v50
    v_xor_b32 v55, v55, v51
    v_lshlrev_b32 v55, 4, v55
    v_lshl_add_u32 v55, v50, 7, v55
    s_lshl_b32 s80, s66, 13
    s_add_u32 s80, s80, 32768
    v_add_u32 v9, s80, v55
    v_xor_b32 v10, 64, v9
    v_lshl_add_u32 v55, v51, 2, v53
    v_and_b32 v46, 7, v55
    v_lshlrev_b32 v46, 1, v46
    s_lshl_b32 s80, s66, 3
    v_add_u32 v47, s80, v47
    v_xor_b32 v46, v46, v47
    v_lshlrev_b32 v46, 4, v46
    v_lshl_add_u32 v46, v55, 8, v46
    v_and_b32 v47, 1, v54
    v_lshl_add_u32 v46, v47, 3, v46
    v_add_u32 v12, 32768, v46
    v_xor_b32 v13, 32, v12
    v_xor_b32 v14, 64, v12
    v_xor_b32 v15, 96, v12
    s_mul_i32 s83, s67, 88
    s_and_b32 s84, s68, 30
    s_add_u32 s83, s83, s84
    s_lshl_b32 s83, s83, 15
    s_lshl_b32 s84, s65, 13
    s_add_u32 s83, s83, s84
    s_lshl_b32 s84, s88, 10
    s_add_u32 s83, s83, s84
    s_add_u32 s84, s83, 32768
    v_lshrrev_b32 v33, 4, v0
    v_and_b32 v45, 1, v33
    v_lshlrev_b32 v45, 2, v45
    v_lshrrev_b32 v46, 1, v33
    v_lshl_or_b32 v45, v46, 4, v45
    v_add_u32 v46, 0, v32
    v_xor_b32 v45, v45, v46
    v_lshl_add_u32 v45, v33, 5, v45
    v_lshlrev_b32 v39, 3, v45
    v_add_u32 v40, 4096, v39
    s_cmp_eq_u32 s82, 1
    s_cbranch_scc1 k1_fast0
k1_hp0:
    s_waitcnt vmcnt(0)
    v_xor_b32 v31, s100, v31
    v_and_b32 v31, v31, v43
    v_cmp_ne_u32 vcc, 0, v31
    s_nop 3
    s_cbranch_vccz k1_hq0
    s_sleep 1
    buffer_load_dword v31, v30, s[16:19], s70 offen sc1
    s_branch k1_hp0
k1_hq0:
    s_lshl_b32 s73, s85, 15
    s_add_u32 s73, s73, s90
    s_add_u32 m0, s93, 0
    s_nop 0
    buffer_load_dwordx4 v1, s[4:7], s73 offen sc1 lds
    buffer_load_dwordx4 v1, s[4:7], s73 offen offset:1024 sc1 lds
    s_add_u32 m0, s94, 0
    s_nop 0
    buffer_load_dwordx4 v2, s[4:7], s73 offen sc1 lds
    buffer_load_dwordx4 v2, s[4:7], s73 offen offset:1024 sc1 lds
    s_cmp_eq_u32 s77, 1
    s_cbranch_scc1 k1_adone0
    s_branch k1_agc0
k1_fast0:
    s_cmp_eq_u32 s77, 1
    s_cbranch_scc1 k1_adone0
k1_agw0:
    s_waitcnt vmcnt(0)
k1_agc0:
    v_xor_b32 v44, s100, v242
    v_xor_b32 v45, s100, v246
    v_and_b32 v44, v44, v253
    v_and_or_b32 v44, v45, v254, v44
    v_cmp_ne_u32 vcc, 0, v44
    s_nop 3
    s_cbranch_vccz k1_adone0
    s_sleep 1
    buffer_load_dwordx4 v[240:243], v27, s[20:23], 0 offen sc1
    buffer_load_dwordx4 v[244:247], v252, s[20:23], 0 offen sc1
    s_branch k1_agw0
k1_adone0:
    v_mul_f32 v248, v18, v240
    v_mul_f32 v249, v18, v241
    v_fma_f32 v248, -v19, v241, v248
    v_fmac_f32 v249, v19, v240
    v_fmac_f32 v248, v34, v244
    v_fmac_f32 v249, v34, v245
    v_fma_f32 v248, -v35, v245, v248
    v_fmac_f32 v249, v35, v244
    v_mov_b32 v250, v248
    v_mov_b32 v251, v249
    s_nop 0
    v_permlane32_swap_b32 v248, v250
    v_permlane32_swap_b32 v249, v251
    v_add_f32 v248, v248, v250
    v_add_f32 v249, v249, v251
    v_mov_b32 v250, v248
    v_mov_b32 v251, v249
    s_nop 0
    v_permlane16_swap_b32 v248, v250
    v_permlane16_swap_b32 v249, v251
    v_add_f32 v248, v248, v250
    v_add_f32 v249, v249, v251
    v_fmac_f32 v28, v20, v248
    v_fmac_f32 v29, v20, v249
    v_fma_f32 v28, -v21, v249, v28
    v_fmac_f32 v29, v21, v248
    v_mul_f32 v46, v22, v28
    v_mul_f32 v47, v22, v29
    v_fma_f32 v46, -v23, v29, v46
    v_fmac_f32 v47, v23, v28
    v_fmac_f32 v64, v160, v46
    v_fma_f32 v80, -v160, v47, v80
    v_fma_f32 v64, -v161, v47, v64
    v_fma_f32 v80, -v161, v46, v80
    v_fmac_f32 v65, v162, v46
    v_fma_f32 v81, -v162, v47, v81
    v_fma_f32 v65, -v163, v47, v65
    v_fma_f32 v81, -v163, v46, v81
    v_fmac_f32 v66, v164, v46
    v_fma_f32 v82, -v164, v47, v82
    v_fma_f32 v66, -v165, v47, v66
    v_fma_f32 v82, -v165, v46, v82
    v_fmac_f32 v67, v166, v46
    v_fma_f32 v83, -v166, v47, v83
    v_fma_f32 v67, -v167, v47, v67
    v_fma_f32 v83, -v167, v46, v83
    v_fmac_f32 v68, v168, v46
    v_fma_f32 v84, -v168, v47, v84
    v_fma_f32 v68, -v169, v47, v68
    v_fma_f32 v84, -v169, v46, v84
    v_fmac_f32 v69, v170, v46
    v_fma_f32 v85, -v170, v47, v85
    v_fma_f32 v69, -v171, v47, v69
    v_fma_f32 v85, -v171, v46, v85
    v_fmac_f32 v70, v172, v46
    v_fma_f32 v86, -v172, v47, v86
    v_fma_f32 v70, -v173, v47, v70
    v_fma_f32 v86, -v173, v46, v86
    v_fmac_f32 v71, v174, v46
    v_fma_f32 v87, -v174, v47, v87
    v_fma_f32 v71, -v175, v47, v71
    v_fma_f32 v87, -v175, v46, v87
    v_fmac_f32 v72, v176, v46
    v_fma_f32 v88, -v176, v47, v88
    v_fma_f32 v72, -v177, v47, v72
    v_fma_f32 v88, -v177, v46, v88
    v_fmac_f32 v73, v178, v46
    v_fma_f32 v89, -v178, v47, v89
    v_fma_f32 v73, -v179, v47, v73
    v_fma_f32 v89, -v179, v46, v89
    v_fmac_f32 v74, v180, v46
    v_fma_f32 v90, -v180, v47, v90
    v_fma_f32 v74, -v181, v47, v74
    v_fma_f32 v90, -v181, v46, v90
    v_fmac_f32 v75, v182, v46
    v_fma_f32 v91, -v182, v47, v91
    v_fma_f32 v75, -v183, v47, v75
    v_fma_f32 v91, -v183, v46, v91
    v_fmac_f32 v76, v184, v46
    v_fma_f32 v92, -v184, v47, v92
    v_fma_f32 v76, -v185, v47, v76
    v_fma_f32 v92, -v185, v46, v92
    v_fmac_f32 v77, v186, v46
    v_fma_f32 v93, -v186, v47, v93
    v_fma_f32 v77, -v187, v47, v77
    v_fma_f32 v93, -v187, v46, v93
    v_fmac_f32 v78, v188, v46
    v_fma_f32 v94, -v188, v47, v94
    v_fma_f32 v78, -v189, v47, v78
    v_fma_f32 v94, -v189, v46, v94
    v_fmac_f32 v79, v190, v46
    v_fma_f32 v95, -v190, v47, v95
    v_fma_f32 v79, -v191, v47, v79
    v_fma_f32 v95, -v191, v46, v95
    s_cmp_eq_u32 s82, 1
    s_cbranch_scc1 k2_start
    s_lshl_b32 s73, s86, 15
    s_add_u32 s73, s73, s90
    s_add_u32 m0, s93, 49152
    s_nop 0
    buffer_load_dwordx4 v1, s[4:7], s73 offen sc1 lds
    buffer_load_dwordx4 v1, s[4:7], s73 offen offset:1024 sc1 lds
    s_add_u32 m0, s94, 49152
    s_nop 0
    buffer_load_dwordx4 v2, s[4:7], s73 offen sc1 lds
    buffer_load_dwordx4 v2, s[4:7], s73 offen offset:1024 sc1 lds
    s_branch k2_start
k1_c1:
    ds_read_b128 v[160:163], v50 offset:0
    ds_read_b128 v[176:179], v52 offset:0
    ds_read_b128 v[164:167], v50 offset:2048
    ds_read_b128 v[168:171], v50 offset:4096
    ds_read_b128 v[172:175], v50 offset:6144
    ds_read_b128 v[180:183], v52 offset:2048
    ds_read_b64_tr_b16 v[184:185], v54 offset:0
    ds_read_b64_tr_b16 v[186:187], v54 offset:1792
    ds_read_b64_tr_b16 v[188:189], v54 offset:32
    ds_read_b64_tr_b16 v[190:191], v54 offset:1824
    ds_read_b64_tr_b16 v[192:193], v55 offset:0
    ds_read_b64_tr_b16 v[194:195], v55 offset:1792
    s_waitcnt lgkmcnt(0)
    v_mfma_f32_16x16x32_bf16 v[64:67], v[160:163], v[176:179], 0
    ds_read_b128 v[200:203], v51 offset:0
    v_mfma_f32_16x16x32_bf16 v[68:71], v[164:167], v[176:179], 0
    ds_read_b128 v[216:219], v53 offset:0
    v_mfma_f32_16x16x32_bf16 v[72:75], v[168:171], v[176:179], 0
    ds_read_b128 v[204:207], v51 offset:2048
    s_add_u32 m0, s93, s73
    s_nop 0
    buffer_load_dwordx4 v1, s[4:7], s70 offen  lds
    v_mfma_f32_16x16x32_bf16 v[76:79], v[172:175], v[176:179], 0
    ds_read_b128 v[208:211], v51 offset:4096
    v_mfma_f32_16x16x32_bf16 v[80:83], v[160:163], v[180:183], 0
    ds_read_b128 v[212:215], v51 offset:6144
    s_add_u32 m0, s93, s100
    s_nop 0
    buffer_load_dwordx4 v2, s[4:7], s70 offen  lds
    v_mfma_f32_16x16x32_bf16 v[84:87], v[164:167], v[180:183], 0
    ds_read_b128 v[220:223], v53 offset:2048
    v_mfma_f32_16x16x32_bf16 v[88:91], v[168:171], v[180:183], 0
    ds_read_b64_tr_b16 v[224:225], v54 offset:7168
    v_mfma_f32_16x16x32_bf16 v[92:95], v[172:175], v[180:183], 0
    ds_read_b64_tr_b16 v[226:227], v54 offset:8960
    s_add_u32 m0, s93, s101
    s_nop 0
    buffer_load_dwordx4 v3, s[4:7], s70 offen  lds
    v_mfma_f32_16x16x32_bf16 v[96:99], v[184:187], v[160:163], 0
    ds_read_b64_tr_b16 v[228:229], v54 offset:7200
    v_mfma_f32_16x16x32_bf16 v[100:103], v[184:187], v[164:167], 0
    ds_read_b64_tr_b16 v[230:231], v54 offset:8992
    v_mfma_f32_16x16x32_bf16 v[104:107], v[184:187], v[168:171], 0
    ds_read_b64_tr_b16 v[232:233], v55 offset:7168
    s_add_u32 m0, s93, s78
    s_nop 0
    buffer_load_dwordx4 v4, s[4:7], s70 offen  lds
    v_mfma_f32_16x16x32_bf16 v[108:111], v[184:187], v[172:175], 0
    ds_read_b64_tr_b16 v[234:235], v55 offset:8960
    v_mfma_f32_16x16x32_bf16 v[112:115], v[188:191], v[160:163], 0
    v_mfma_f32_16x16x32_bf16 v[116:119], v[188:191], v[164:167], 0
    s_add_u32 m0, s93, s75
    s_add_u32 s70, s70, 128
    buffer_load_dwordx4 v6, s[12:15], s71 offen  lds
    v_mfma_f32_16x16x32_bf16 v[120:123], v[188:191], v[168:171], 0
    v_mfma_f32_16x16x32_bf16 v[124:127], v[188:191], v[172:175], 0
    v_mfma_f32_16x16x32_bf16 v[128:131], v[192:195], v[160:163], 0
    s_mul_i32 s97, s93, s77
    s_add_u32 m0, s97, s76
    s_nop 0
    buffer_load_dwordx4 v7, s[12:15], s71 offen  lds
    s_add_u32 s71, s71, 458752
    v_mfma_f32_16x16x32_bf16 v[132:135], v[192:195], v[164:167], 0
    v_mfma_f32_16x16x32_bf16 v[136:139], v[192:195], v[168:171], 0
    v_mfma_f32_16x16x32_bf16 v[140:143], v[192:195], v[172:175], 0
    s_lshl_b32 s85, s67, 8
    s_lshl_b32 s87, s68, 3
    s_add_u32 s87, s87, s85
    s_add_u32 s87, s87, s64
    s_lshl_b32 s85, s87, 11
    v_lshlrev_b32 v40, 5, v0
    buffer_load_dwordx4 v[240:243], v40, s[4:7], s85 offen
    buffer_load_dwordx4 v[244:247], v40, s[4:7], s85 offen offset:16
    buffer_load_dwordx4 v[248:251], v40, s[20:23], 0 offen
    buffer_load_dwordx4 v[252:255], v40, s[20:23], 0 offen offset:16
    v_and_b32 v41, 15, v0
    v_add_u32 v37, s83, v41
    v_lshlrev_b32 v37, 1, v37
    v_and_b32 v38, 31, v0
    s_lshl_b32 s85, s68, 5
    v_add_u32 v38, s85, v38
    v_lshlrev_b32 v38, 1, v38
    s_mov_b32 s28, s34
    s_mov_b32 s29, s35
    s_mov_b32 s30, 2048
    s_mov_b32 s31, 0x00020000
    buffer_load_ushort v27, v37, s[28:31], 0 offen
    buffer_load_ushort v30, v38, s[28:31], 0 offen
    s_nop 0
    s_mov_b32 s28, s36
    s_mov_b32 s29, s37
    s_mov_b32 s30, 2048
    s_mov_b32 s31, 0x00020000
    buffer_load_ushort v28, v37, s[28:31], 0 offen
    buffer_load_ushort v31, v38, s[28:31], 0 offen
    s_nop 0
    s_mov_b32 s28, s46
    s_mov_b32 s29, s47
    s_mov_b32 s30, 2048
    s_mov_b32 s31, 0x00020000
    buffer_load_ushort v29, v37, s[28:31], 0 offen
    buffer_load_ushort v32, v38, s[28:31], 0 offen
    s_nop 0
    s_waitcnt vmcnt(16) lgkmcnt(0)
    s_barrier
    s_mov_b32 s93, s96
    s_mov_b32 s96, s95
    v_add_u32 v50, s95, v8
    v_xor_b32 v52, 0x2000, v52
    v_add_u32 v54, s95, v12
    v_add_u32 v55, s95, v13
    v_mfma_f32_16x16x32_bf16 v[64:67], v[200:203], v[216:219], v[64:67]
    ds_read_b128 v[160:163], v50 offset:0
    v_add_u32 v51, s95, v9
    v_xor_b32 v53, 0x2000, v53
    v_mfma_f32_16x16x32_bf16 v[68:71], v[204:207], v[216:219], v[68:71]
    ds_read_b128 v[176:179], v52 offset:0
    s_add_u32 m0, s94, s74
    s_nop 0
    buffer_load_dwordx4 v5, s[8:11], s72 offen  lds
    s_add_u32 s72, s72, 128
    s_xor_b32 s94, s94, 0x2000
    v_mfma_f32_16x16x32_bf16 v[72:75], v[208:211], v[216:219], v[72:75]
    ds_read_b128 v[164:167], v50 offset:2048
    s_add_u32 s95, s95, 47104
    s_cmp_lt_u32 s95, 141312
    s_cselect_b32 s95, s95, 0
    v_mfma_f32_16x16x32_bf16 v[76:79], v[212:215], v[216:219], v[76:79]
    ds_read_b128 v[168:171], v50 offset:4096
    s_add_u32 m0, s93, s73
    s_nop 0
    buffer_load_dwordx4 v1, s[4:7], s70 offen  lds
    v_mfma_f32_16x16x32_bf16 v[80:83], v[200:203], v[220:223], v[80:83]
    ds_read_b128 v[172:175], v50 offset:6144
    v_mfma_f32_16x16x32_bf16 v[84:87], v[204:207], v[220:223], v[84:87]
    ds_read_b128 v[180:183], v52 offset:2048
    v_mfma_f32_16x16x32_bf16 v[88:91], v[208:211], v[220:223], v[88:91]
    ds_read_b64_tr_b16 v[184:185], v54 offset:0
    v_mfma_f32_16x16x32_bf16 v[92:95], v[212:215], v[220:223], v[92:95]
    ds_read_b64_tr_b16 v[186:187], v54 offset:1792
    v_mfma_f32_16x16x32_bf16 v[96:99], v[224:227], v[200:203], v[96:99]
    ds_read_b64_tr_b16 v[188:189], v54 offset:32
    s_add_u32 m0, s93, s100
    s_nop 0
    buffer_load_dwordx4 v2, s[4:7], s70 offen  lds
    v_mfma_f32_16x16x32_bf16 v[100:103], v[224:227], v[204:207], v[100:103]
    ds_read_b64_tr_b16 v[190:191], v54 offset:1824
    v_mfma_f32_16x16x32_bf16 v[104:107], v[224:227], v[208:211], v[104:107]
    ds_read_b64_tr_b16 v[192:193], v55 offset:0
    v_mfma_f32_16x16x32_bf16 v[108:111], v[224:227], v[212:215], v[108:111]
    ds_read_b64_tr_b16 v[194:195], v55 offset:1792
    v_mfma_f32_16x16x32_bf16 v[112:115], v[228:231], v[200:203], v[112:115]
    v_mfma_f32_16x16x32_bf16 v[116:119], v[228:231], v[204:207], v[116:119]
    s_add_u32 m0, s93, s101
    s_nop 0
    buffer_load_dwordx4 v3, s[4:7], s70 offen  lds
    v_mfma_f32_16x16x32_bf16 v[120:123], v[228:231], v[208:211], v[120:123]
    v_mfma_f32_16x16x32_bf16 v[124:127], v[228:231], v[212:215], v[124:127]
    v_mfma_f32_16x16x32_bf16 v[128:131], v[232:235], v[200:203], v[128:131]
    v_mfma_f32_16x16x32_bf16 v[132:135], v[232:235], v[204:207], v[132:135]
    v_mfma_f32_16x16x32_bf16 v[136:139], v[232:235], v[208:211], v[136:139]
    buffer_load_dword v49, v36, s[24:27], s79 offen
    s_add_u32 s79, s79, s92
    v_mfma_f32_16x16x32_bf16 v[140:143], v[232:235], v[212:215], v[140:143]
k1_loop1:
    s_waitcnt lgkmcnt(0)
    v_mfma_f32_16x16x32_bf16 v[64:67], v[160:163], v[176:179], v[64:67]
    ds_read_b128 v[200:203], v51 offset:0
    v_mfma_f32_16x16x32_bf16 v[68:71], v[164:167], v[176:179], v[68:71]
    ds_read_b128 v[216:219], v53 offset:0
    v_mfma_f32_16x16x32_bf16 v[72:75], v[168:171], v[176:179], v[72:75]
    ds_read_b128 v[204:207], v51 offset:2048
    v_mfma_f32_16x16x32_bf16 v[76:79], v[172:175], v[176:179], v[76:79]
    ds_read_b128 v[208:211], v51 offset:4096
    v_mfma_f32_16x16x32_bf16 v[80:83], v[160:163], v[180:183], v[80:83]
    ds_read_b128 v[212:215], v51 offset:6144
    s_add_u32 m0, s93, s78
    s_nop 0
    buffer_load_dwordx4 v4, s[4:7], s70 offen  lds
    v_mfma_f32_16x16x32_bf16 v[84:87], v[164:167], v[180:183], v[84:87]
    ds_read_b128 v[220:223], v53 offset:2048
    v_mfma_f32_16x16x32_bf16 v[88:91], v[168:171], v[180:183], v[88:91]
    ds_read_b64_tr_b16 v[224:225], v54 offset:7168
    v_mfma_f32_16x16x32_bf16 v[92:95], v[172:175], v[180:183], v[92:95]
    ds_read_b64_tr_b16 v[226:227], v54 offset:8960
    v_mfma_f32_16x16x32_bf16 v[96:99], v[184:187], v[160:163], v[96:99]
    ds_read_b64_tr_b16 v[228:229], v54 offset:7200
    v_mfma_f32_16x16x32_bf16 v[100:103], v[184:187], v[164:167], v[100:103]
    ds_read_b64_tr_b16 v[230:231], v54 offset:8992
    v_mfma_f32_16x16x32_bf16 v[104:107], v[184:187], v[168:171], v[104:107]
    ds_read_b64_tr_b16 v[232:233], v55 offset:7168
    v_mfma_f32_16x16x32_bf16 v[108:111], v[184:187], v[172:175], v[108:111]
    ds_read_b64_tr_b16 v[234:235], v55 offset:8960
    s_add_u32 m0, s93, s75
    s_add_u32 s70, s70, 128
    buffer_load_dwordx4 v6, s[12:15], s71 offen  lds
    v_mfma_f32_16x16x32_bf16 v[112:115], v[188:191], v[160:163], v[112:115]
    v_mfma_f32_16x16x32_bf16 v[116:119], v[188:191], v[164:167], v[116:119]
    v_mfma_f32_16x16x32_bf16 v[120:123], v[188:191], v[168:171], v[120:123]
    v_mfma_f32_16x16x32_bf16 v[124:127], v[188:191], v[172:175], v[124:127]
    v_mfma_f32_16x16x32_bf16 v[128:131], v[192:195], v[160:163], v[128:131]
    v_mfma_f32_16x16x32_bf16 v[132:135], v[192:195], v[164:167], v[132:135]
    v_mfma_f32_16x16x32_bf16 v[136:139], v[192:195], v[168:171], v[136:139]
    s_mul_i32 s97, s93, s77
    s_add_u32 m0, s97, s76
    s_nop 0
    buffer_load_dwordx4 v7, s[12:15], s71 offen  lds
    s_add_u32 s71, s71, 458752
    v_mfma_f32_16x16x32_bf16 v[140:143], v[192:195], v[172:175], v[140:143]
    s_waitcnt vmcnt(7) lgkmcnt(0)
    s_barrier
    s_mov_b32 s93, s96
    s_mov_b32 s96, s95
    v_add_u32 v50, s95, v8
    v_xor_b32 v52, 0x2000, v52
    v_add_u32 v54, s95, v12
    v_add_u32 v55, s95, v13
    v_mfma_f32_16x16x32_bf16 v[64:67], v[200:203], v[216:219], v[64:67]
    ds_read_b128 v[160:163], v50 offset:0
    v_add_u32 v51, s95, v9
    v_xor_b32 v53, 0x2000, v53
    v_mfma_f32_16x16x32_bf16 v[68:71], v[204:207], v[216:219], v[68:71]
    ds_read_b128 v[176:179], v52 offset:0
    s_add_u32 m0, s94, s74
    s_nop 0
    buffer_load_dwordx4 v5, s[8:11], s72 offen  lds
    s_add_u32 s72, s72, 128
    s_xor_b32 s94, s94, 0x2000
    v_mfma_f32_16x16x32_bf16 v[72:75], v[208:211], v[216:219], v[72:75]
    ds_read_b128 v[164:167], v50 offset:2048
    s_add_u32 s95, s95, 47104
    s_cmp_lt_u32 s95, 141312
    s_cselect_b32 s95, s95, 0
    v_mfma_f32_16x16x32_bf16 v[76:79], v[212:215], v[216:219], v[76:79]
    ds_read_b128 v[168:171], v50 offset:4096
    s_add_u32 m0, s93, s73
    s_nop 0
    buffer_load_dwordx4 v1, s[4:7], s70 offen  lds
    v_mfma_f32_16x16x32_bf16 v[80:83], v[200:203], v[220:223], v[80:83]
    ds_read_b128 v[172:175], v50 offset:6144
    v_mfma_f32_16x16x32_bf16 v[84:87], v[204:207], v[220:223], v[84:87]
    ds_read_b128 v[180:183], v52 offset:2048
    v_mfma_f32_16x16x32_bf16 v[88:91], v[208:211], v[220:223], v[88:91]
    ds_read_b64_tr_b16 v[184:185], v54 offset:0
    v_mfma_f32_16x16x32_bf16 v[92:95], v[212:215], v[220:223], v[92:95]
    ds_read_b64_tr_b16 v[186:187], v54 offset:1792
    v_mfma_f32_16x16x32_bf16 v[96:99], v[224:227], v[200:203], v[96:99]
    ds_read_b64_tr_b16 v[188:189], v54 offset:32
    s_add_u32 m0, s93, s100
    s_nop 0
    buffer_load_dwordx4 v2, s[4:7], s70 offen  lds
    v_mfma_f32_16x16x32_bf16 v[100:103], v[224:227], v[204:207], v[100:103]
    ds_read_b64_tr_b16 v[190:191], v54 offset:1824
    v_mfma_f32_16x16x32_bf16 v[104:107], v[224:227], v[208:211], v[104:107]
    ds_read_b64_tr_b16 v[192:193], v55 offset:0
    v_mfma_f32_16x16x32_bf16 v[108:111], v[224:227], v[212:215], v[108:111]
    ds_read_b64_tr_b16 v[194:195], v55 offset:1792
    v_mfma_f32_16x16x32_bf16 v[112:115], v[228:231], v[200:203], v[112:115]
    v_mfma_f32_16x16x32_bf16 v[116:119], v[228:231], v[204:207], v[116:119]
    s_add_u32 m0, s93, s101
    s_nop 0
    buffer_load_dwordx4 v3, s[4:7], s70 offen  lds
    v_mfma_f32_16x16x32_bf16 v[120:123], v[228:231], v[208:211], v[120:123]
    v_mfma_f32_16x16x32_bf16 v[124:127], v[228:231], v[212:215], v[124:127]
    v_mfma_f32_16x16x32_bf16 v[128:131], v[232:235], v[200:203], v[128:131]
    v_mfma_f32_16x16x32_bf16 v[132:135], v[232:235], v[204:207], v[132:135]
    v_mfma_f32_16x16x32_bf16 v[136:139], v[232:235], v[208:211], v[136:139]
    buffer_load_dword v49, v36, s[24:27], s79 offen
    s_add_u32 s79, s79, s92
    v_mfma_f32_16x16x32_bf16 v[140:143], v[232:235], v[212:215], v[140:143]
    s_add_u32 s69, s69, 1
    s_cmp_lt_u32 s69, 12
    s_cbranch_scc1 k1_loop1
    s_waitcnt lgkmcnt(0)
    v_mfma_f32_16x16x32_bf16 v[64:67], v[160:163], v[176:179], v[64:67]
    v_lshlrev_b32 v27, 16, v27
    v_lshlrev_b32 v28, 16, v28
    ds_read_b128 v[200:203], v51 offset:0
    v_mfma_f32_16x16x32_bf16 v[68:71], v[164:167], v[176:179], v[68:71]
    v_lshlrev_b32 v29, 16, v29
    v_mul_f32 v29, 1069066811, v29
    ds_read_b128 v[216:219], v53 offset:0
    v_mfma_f32_16x16x32_bf16 v[72:75], v[168:171], v[176:179], v[72:75]
    v_exp_f32 v29, v29
    s_nop 0
    v_cvt_pk_bf16_f32 v29, v29, v29
    ds_read_b128 v[204:207], v51 offset:2048
    v_mfma_f32_16x16x32_bf16 v[76:79], v[172:175], v[176:179], v[76:79]
    v_lshlrev_b32 v29, 16, v29
    v_mul_f32 v42, v29, v27
    ds_read_b128 v[208:211], v51 offset:4096
    v_mfma_f32_16x16x32_bf16 v[80:83], v[160:163], v[180:183], v[80:83]
    v_mul_f32 v43, v29, v28
    v_mul_f32 v42, 1069066811, v42
    ds_read_b128 v[212:215], v51 offset:6144
    s_add_u32 m0, s93, s78
    s_nop 0
    buffer_load_dwordx4 v4, s[4:7], s70 offen  lds
    v_mfma_f32_16x16x32_bf16 v[84:87], v[164:167], v[180:183], v[84:87]
    v_mul_f32 v43, 1042479491, v43
    v_lshlrev_b32 v30, 16, v30
    ds_read_b128 v[220:223], v53 offset:2048
    v_mfma_f32_16x16x32_bf16 v[88:91], v[168:171], v[180:183], v[88:91]
    v_lshlrev_b32 v31, 16, v31
    v_lshlrev_b32 v32, 16, v32
    ds_read_b64_tr_b16 v[224:225], v54 offset:7168
    v_mfma_f32_16x16x32_bf16 v[92:95], v[172:175], v[180:183], v[92:95]
    v_mul_f32 v32, 1069066811, v32
    v_exp_f32 v32, v32
    ds_read_b64_tr_b16 v[226:227], v54 offset:8960
    v_mfma_f32_16x16x32_bf16 v[96:99], v[184:187], v[160:163], v[96:99]
    v_cvt_pk_bf16_f32 v32, v32, v32
    v_lshlrev_b32 v32, 16, v32
    ds_read_b64_tr_b16 v[228:229], v54 offset:7200
    v_mfma_f32_16x16x32_bf16 v[100:103], v[184:187], v[164:167], v[100:103]
    v_mul_f32 v44, v32, v30
    v_mul_f32 v45, v32, v31
    ds_read_b64_tr_b16 v[230:231], v54 offset:8992
    v_mfma_f32_16x16x32_bf16 v[104:107], v[184:187], v[168:171], v[104:107]
    v_mul_f32 v44, 1069066811, v44
    v_mul_f32 v45, 1042479491, v45
    ds_read_b64_tr_b16 v[232:233], v55 offset:7168
    v_mfma_f32_16x16x32_bf16 v[108:111], v[184:187], v[172:175], v[108:111]
    v_mul_f32 v46, 1.0, v42
    v_mul_f32 v47, 1.0, v43
    ds_read_b64_tr_b16 v[234:235], v55 offset:8960
    s_add_u32 m0, s93, s75
    s_add_u32 s70, s70, 128
    buffer_load_dwordx4 v6, s[12:15], s71 offen  lds
    v_mfma_f32_16x16x32_bf16 v[112:115], v[188:191], v[160:163], v[112:115]
    v_exp_f32 v46, v46
    v_fract_f32 v47, v47
    v_mfma_f32_16x16x32_bf16 v[116:119], v[188:191], v[164:167], v[116:119]
    v_cos_f32 v14, v47
    v_sin_f32 v15, v47
    v_mfma_f32_16x16x32_bf16 v[120:123], v[188:191], v[168:171], v[120:123]
    v_mul_f32 v14, v14, v46
    v_mul_f32 v15, v15, v46
    v_mfma_f32_16x16x32_bf16 v[124:127], v[188:191], v[172:175], v[124:127]
    s_mov_b32 s85, 0x41800000
    s_mov_b32 s86, 0x43800000
    v_mfma_f32_16x16x32_bf16 v[128:131], v[192:195], v[160:163], v[128:131]
    v_cvt_f32_u32 v39, v26
    v_mul_f32 v39, s85, v39
    v_mfma_f32_16x16x32_bf16 v[132:135], v[192:195], v[164:167], v[132:135]
    v_mfma_f32_16x16x32_bf16 v[136:139], v[192:195], v[168:171], v[136:139]
    s_mul_i32 s97, s93, s77
    s_add_u32 m0, s97, s76
    s_nop 0
    buffer_load_dwordx4 v7, s[12:15], s71 offen  lds
    s_add_u32 s71, s71, 458752
    v_mfma_f32_16x16x32_bf16 v[140:143], v[192:195], v[172:175], v[140:143]
    s_waitcnt vmcnt(7) lgkmcnt(0)
    s_barrier
    s_mov_b32 s93, s96
    s_mov_b32 s96, s95
    v_add_u32 v50, s95, v8
    v_xor_b32 v52, 0x2000, v52
    v_add_u32 v54, s95, v12
    v_add_u32 v55, s95, v13
    v_mfma_f32_16x16x32_bf16 v[64:67], v[200:203], v[216:219], v[64:67]
    v_mul_f32 v46, s85, v42
    v_mul_f32 v47, s85, v43
    ds_read_b128 v[160:163], v50 offset:0
    v_add_u32 v51, s95, v9
    v_xor_b32 v53, 0x2000, v53
    v_mfma_f32_16x16x32_bf16 v[68:71], v[204:207], v[216:219], v[68:71]
    v_exp_f32 v46, v46
    v_fract_f32 v47, v47
    ds_read_b128 v[176:179], v52 offset:0
    s_add_u32 m0, s94, s74
    s_nop 0
    buffer_load_dwordx4 v5, s[8:11], s72 offen  lds
    s_add_u32 s72, s72, 128
    s_xor_b32 s94, s94, 0x2000
    v_mfma_f32_16x16x32_bf16 v[72:75], v[208:211], v[216:219], v[72:75]
    v_cos_f32 v16, v47
    v_sin_f32 v17, v47
    ds_read_b128 v[164:167], v50 offset:2048
    s_add_u32 s95, s95, 47104
    s_cmp_lt_u32 s95, 141312
    s_cselect_b32 s95, s95, 0
    v_mfma_f32_16x16x32_bf16 v[76:79], v[212:215], v[216:219], v[76:79]
    v_mul_f32 v16, v16, v46
    v_mul_f32 v17, v17, v46
    ds_read_b128 v[168:171], v50 offset:4096
    v_mfma_f32_16x16x32_bf16 v[80:83], v[200:203], v[220:223], v[80:83]
    v_lshrrev_b32 v34, 4, v0
    v_sub_u32 v35, 6, v34
    ds_read_b128 v[172:175], v50 offset:6144
    v_mfma_f32_16x16x32_bf16 v[84:87], v[204:207], v[220:223], v[84:87]
    v_cvt_f32_u32 v35, v35
    v_mul_f32 v35, s86, v35
    ds_read_b128 v[180:183], v52 offset:2048
    v_mfma_f32_16x16x32_bf16 v[88:91], v[208:211], v[220:223], v[88:91]
    v_mul_f32 v46, v35, v42
    v_mul_f32 v47, v35, v43
    ds_read_b64_tr_b16 v[184:185], v54 offset:0
    v_mfma_f32_16x16x32_bf16 v[92:95], v[212:215], v[220:223], v[92:95]
    v_exp_f32 v46, v46
    v_fract_f32 v47, v47
    ds_read_b64_tr_b16 v[186:187], v54 offset:1792
    v_mfma_f32_16x16x32_bf16 v[96:99], v[224:227], v[200:203], v[96:99]
    v_cos_f32 v18, v47
    v_sin_f32 v19, v47
    ds_read_b64_tr_b16 v[188:189], v54 offset:32
    v_mfma_f32_16x16x32_bf16 v[100:103], v[224:227], v[204:207], v[100:103]
    v_mul_f32 v18, v18, v46
    v_mul_f32 v19, v19, v46
    ds_read_b64_tr_b16 v[190:191], v54 offset:1824
    v_mfma_f32_16x16x32_bf16 v[104:107], v[224:227], v[208:211], v[104:107]
    v_add_f32 v35, 0xc4800000, v35
    v_max_f32 v37, 0, v35
    ds_read_b64_tr_b16 v[192:193], v55 offset:0
    v_mfma_f32_16x16x32_bf16 v[108:111], v[224:227], v[212:215], v[108:111]
    v_mul_f32 v46, v37, v42
    v_mul_f32 v47, v37, v43
    ds_read_b64_tr_b16 v[194:195], v55 offset:1792
    v_mfma_f32_16x16x32_bf16 v[112:115], v[228:231], v[200:203], v[112:115]
    v_exp_f32 v46, v46
    v_fract_f32 v47, v47
    v_mfma_f32_16x16x32_bf16 v[116:119], v[228:231], v[204:207], v[116:119]
    v_cos_f32 v34, v47
    v_sin_f32 v35, v47
    v_mfma_f32_16x16x32_bf16 v[120:123], v[228:231], v[208:211], v[120:123]
    v_mul_f32 v34, v34, v46
    v_mul_f32 v35, v35, v46
    v_mfma_f32_16x16x32_bf16 v[124:127], v[228:231], v[212:215], v[124:127]
    v_mul_f32 v46, v39, v42
    v_mul_f32 v47, v39, v43
    v_mfma_f32_16x16x32_bf16 v[128:131], v[232:235], v[200:203], v[128:131]
    v_exp_f32 v46, v46
    v_fract_f32 v47, v47
    v_mfma_f32_16x16x32_bf16 v[132:135], v[232:235], v[204:207], v[132:135]
    v_mfma_f32_16x16x32_bf16 v[136:139], v[232:235], v[208:211], v[136:139]
    v_mfma_f32_16x16x32_bf16 v[140:143], v[232:235], v[212:215], v[140:143]
    s_waitcnt lgkmcnt(0)
    v_mfma_f32_16x16x32_bf16 v[96:99], v[184:187], v[160:163], v[96:99]
    v_cos_f32 v20, v47
    v_sin_f32 v21, v47
    v_mul_f32 v20, v20, v46
    ds_read_b128 v[200:203], v51 offset:0
    v_mfma_f32_16x16x32_bf16 v[100:103], v[184:187], v[164:167], v[100:103]
    v_mul_f32 v21, v21, v46
    v_mul_f32 v46, s85, v44
    v_mul_f32 v47, s85, v45
    ds_read_b128 v[204:207], v51 offset:2048
    v_mfma_f32_16x16x32_bf16 v[104:107], v[184:187], v[168:171], v[104:107]
    v_exp_f32 v46, v46
    v_fract_f32 v47, v47
    v_cos_f32 v24, v47
    ds_read_b128 v[208:211], v51 offset:4096
    v_mfma_f32_16x16x32_bf16 v[108:111], v[184:187], v[172:175], v[108:111]
    v_sin_f32 v25, v47
    v_mul_f32 v24, v24, v46
    v_mul_f32 v25, v25, v46
    ds_read_b128 v[212:215], v51 offset:6144
    v_mfma_f32_16x16x32_bf16 v[112:115], v[188:191], v[160:163], v[112:115]
    v_mul_f32 v46, v27, v27
    v_fmac_f32 v46, v28, v28
    v_rcp_f32 v46, v46
    ds_read_b64_tr_b16 v[224:225], v54 offset:7168
    v_mfma_f32_16x16x32_bf16 v[116:119], v[188:191], v[164:167], v[116:119]
    v_add_f32 v47, -1.0, v14
    v_mul_f32 v22, v47, v27
    v_fmac_f32 v22, v15, v28
    ds_read_b64_tr_b16 v[226:227], v54 offset:8960
    v_mfma_f32_16x16x32_bf16 v[120:123], v[188:191], v[168:171], v[120:123]
    v_mul_f32 v23, v15, v27
    v_fma_f32 v23, -v47, v28, v23
    v_add_f32 v46, v46, v46
    ds_read_b64_tr_b16 v[228:229], v54 offset:7200
    v_mfma_f32_16x16x32_bf16 v[124:127], v[188:191], v[172:175], v[124:127]
    v_mul_f32 v22, v22, v46
    v_mul_f32 v23, v23, v46
    v_mov_b32 v40, 0
    ds_read_b64_tr_b16 v[230:231], v54 offset:8992
    v_mfma_f32_16x16x32_bf16 v[128:131], v[192:195], v[160:163], v[128:131]
    v_mov_b32 v41, 0
    v_lshlrev_b32 v42, 16, v240
    v_and_b32 v43, 0xffff0000, v240
    ds_read_b64_tr_b16 v[232:233], v55 offset:7168
    v_mfma_f32_16x16x32_bf16 v[132:135], v[192:195], v[164:167], v[132:135]
    v_lshlrev_b32 v44, 16, v248
    v_and_b32 v45, 0xffff0000, v248
    v_mul_f32 v42, v42, v44
    ds_read_b64_tr_b16 v[234:235], v55 offset:8960
    v_mfma_f32_16x16x32_bf16 v[136:139], v[192:195], v[168:171], v[136:139]
    v_mul_f32 v43, v43, v45
    v_cvt_pk_bf16_f32 v42, v42, v43
    v_lshlrev_b32 v43, 16, v42
    v_mfma_f32_16x16x32_bf16 v[140:143], v[192:195], v[172:175], v[140:143]
    v_and_b32 v42, 0xffff0000, v42
    s_waitcnt vmcnt(0) lgkmcnt(0)
    s_barrier
    s_mov_b32 s93, s96
    s_mov_b32 s96, s95
    v_add_u32 v50, s95, v8
    v_xor_b32 v52, 0x2000, v52
    v_add_u32 v54, s95, v12
    v_add_u32 v55, s95, v13
    v_mfma_f32_16x16x32_bf16 v[96:99], v[224:227], v[200:203], v[96:99]
    v_add_f32 v40, v40, v43
    v_add_f32 v41, v41, v42
    v_lshlrev_b32 v42, 16, v241
    ds_read_b128 v[160:163], v50 offset:0
    v_add_u32 v51, s95, v9
    v_xor_b32 v53, 0x2000, v53
    v_mfma_f32_16x16x32_bf16 v[100:103], v[224:227], v[204:207], v[100:103]
    v_and_b32 v43, 0xffff0000, v241
    v_lshlrev_b32 v44, 16, v249
    v_and_b32 v45, 0xffff0000, v249
    ds_read_b128 v[164:167], v50 offset:2048
    s_add_u32 s95, s95, 47104
    s_cmp_lt_u32 s95, 141312
    s_cselect_b32 s95, s95, 0
    v_mfma_f32_16x16x32_bf16 v[104:107], v[224:227], v[208:211], v[104:107]
    v_mul_f32 v42, v42, v44
    v_mul_f32 v43, v43, v45
    v_cvt_pk_bf16_f32 v42, v42, v43
    ds_read_b128 v[168:171], v50 offset:4096
    s_mov_b32 s28, s60
    s_mov_b32 s29, s61
    s_mov_b32 s30, 256
    s_mov_b32 s31, 0x00020000
    v_mov_b32 v33, 0
    v_mfma_f32_16x16x32_bf16 v[108:111], v[224:227], v[212:215], v[108:111]
    v_lshlrev_b32 v43, 16, v42
    v_and_b32 v42, 0xffff0000, v42
    v_add_f32 v40, v40, v43
    ds_read_b128 v[172:175], v50 offset:6144
    v_mfma_f32_16x16x32_bf16 v[112:115], v[228:231], v[200:203], v[112:115]
    v_add_f32 v41, v41, v42
    v_lshlrev_b32 v42, 16, v242
    v_and_b32 v43, 0xffff0000, v242
    buffer_load_dword v48, v33, s[28:31], 0 offen sc1
    v_mfma_f32_16x16x32_bf16 v[116:119], v[228:231], v[204:207], v[116:119]
    v_lshlrev_b32 v44, 16, v250
    v_and_b32 v45, 0xffff0000, v250
    v_mul_f32 v42, v42, v44
    ds_read_b64_tr_b16 v[184:185], v54 offset:0
    v_mfma_f32_16x16x32_bf16 v[120:123], v[228:231], v[208:211], v[120:123]
    v_mul_f32 v43, v43, v45
    v_cvt_pk_bf16_f32 v42, v42, v43
    v_lshlrev_b32 v43, 16, v42
    ds_read_b64_tr_b16 v[186:187], v54 offset:1792
    v_mfma_f32_16x16x32_bf16 v[124:127], v[228:231], v[212:215], v[124:127]
    v_and_b32 v42, 0xffff0000, v42
    v_add_f32 v40, v40, v43
    v_add_f32 v41, v41, v42
    ds_read_b64_tr_b16 v[188:189], v54 offset:32
    v_mfma_f32_16x16x32_bf16 v[128:131], v[232:235], v[200:203], v[128:131]
    v_lshlrev_b32 v42, 16, v243
    v_and_b32 v43, 0xffff0000, v243
    v_lshlrev_b32 v44, 16, v251
    ds_read_b64_tr_b16 v[190:191], v54 offset:1824
    v_mfma_f32_16x16x32_bf16 v[132:135], v[232:235], v[204:207], v[132:135]
    v_and_b32 v45, 0xffff0000, v251
    v_mul_f32 v42, v42, v44
    v_mul_f32 v43, v43, v45
    ds_read_b64_tr_b16 v[192:193], v55 offset:0
    v_mfma_f32_16x16x32_bf16 v[136:139], v[232:235], v[208:211], v[136:139]
    v_cvt_pk_bf16_f32 v42, v42, v43
    v_lshlrev_b32 v43, 16, v42
    v_and_b32 v42, 0xffff0000, v42
    ds_read_b64_tr_b16 v[194:195], v55 offset:1792
    v_mfma_f32_16x16x32_bf16 v[140:143], v[232:235], v[212:215], v[140:143]
    v_add_f32 v40, v40, v43
    s_waitcnt lgkmcnt(0)
    v_mfma_f32_16x16x32_bf16 v[96:99], v[184:187], v[160:163], v[96:99]
    v_add_f32 v41, v41, v42
    v_lshlrev_b32 v42, 16, v244
    v_and_b32 v43, 0xffff0000, v244
    ds_read_b128 v[200:203], v51 offset:0
    v_mfma_f32_16x16x32_bf16 v[100:103], v[184:187], v[164:167], v[100:103]
    v_lshlrev_b32 v44, 16, v252
    v_and_b32 v45, 0xffff0000, v252
    v_mul_f32 v42, v42, v44
    ds_read_b128 v[204:207], v51 offset:2048
    v_mfma_f32_16x16x32_bf16 v[104:107], v[184:187], v[168:171], v[104:107]
    v_mul_f32 v43, v43, v45
    v_cvt_pk_bf16_f32 v42, v42, v43
    v_lshlrev_b32 v43, 16, v42
    ds_read_b128 v[208:211], v51 offset:4096
    v_mfma_f32_16x16x32_bf16 v[108:111], v[184:187], v[172:175], v[108:111]
    v_and_b32 v42, 0xffff0000, v42
    v_add_f32 v40, v40, v43
    v_add_f32 v41, v41, v42
    ds_read_b128 v[212:215], v51 offset:6144
    v_mfma_f32_16x16x32_bf16 v[112:115], v[188:191], v[160:163], v[112:115]
    v_lshlrev_b32 v42, 16, v245
    v_and_b32 v43, 0xffff0000, v245
    v_lshlrev_b32 v44, 16, v253
    ds_read_b64_tr_b16 v[224:225], v54 offset:7168
    v_mfma_f32_16x16x32_bf16 v[116:119], v[188:191], v[164:167], v[116:119]
    v_and_b32 v45, 0xffff0000, v253
    v_mul_f32 v42, v42, v44
    v_mul_f32 v43, v43, v45
    ds_read_b64_tr_b16 v[226:227], v54 offset:8960
    v_mfma_f32_16x16x32_bf16 v[120:123], v[188:191], v[168:171], v[120:123]
    v_cvt_pk_bf16_f32 v42, v42, v43
    v_lshlrev_b32 v43, 16, v42
    v_and_b32 v42, 0xffff0000, v42
    ds_read_b64_tr_b16 v[228:229], v54 offset:7200
    v_mfma_f32_16x16x32_bf16 v[124:127], v[188:191], v[172:175], v[124:127]
    v_add_f32 v40, v40, v43
    v_add_f32 v41, v41, v42
    v_lshlrev_b32 v42, 16, v246
    ds_read_b64_tr_b16 v[230:231], v54 offset:8992
    v_mfma_f32_16x16x32_bf16 v[128:131], v[192:195], v[160:163], v[128:131]
    v_and_b32 v43, 0xffff0000, v246
    v_lshlrev_b32 v44, 16, v254
    v_and_b32 v45, 0xffff0000, v254
    ds_read_b64_tr_b16 v[232:233], v55 offset:7168
    v_mfma_f32_16x16x32_bf16 v[132:135], v[192:195], v[164:167], v[132:135]
    v_mul_f32 v42, v42, v44
    v_mul_f32 v43, v43, v45
    v_cvt_pk_bf16_f32 v42, v42, v43
    ds_read_b64_tr_b16 v[234:235], v55 offset:8960
    s_mul_i32 s80, s68, 112
    s_add_u32 s81, s80, s89
    s_lshr_b32 s81, s81, 5
    s_add_u32 s82, s80, s91
    s_lshr_b32 s82, s82, 5
    s_mul_i32 s83, s67, 88
    s_add_u32 s83, s83, 32
    s_lshl_b32 s83, s83, 15
    s_lshl_b32 s84, s65, 13
    s_add_u32 s83, s83, s84
    v_lshlrev_b32 v1, 4, v0
    v_add_u32 v2, 4096, v1
    s_lshl_b32 s84, s88, 3
    v_add_u32 v3, s84, v1
    v_add_u32 v4, s84, v2
    v_add_u32 v5, 94208, v8
    v_add_u32 v6, 94208, v9
    v_mfma_f32_16x16x32_bf16 v[136:139], v[192:195], v[168:171], v[136:139]
    v_lshlrev_b32 v43, 16, v42
    v_and_b32 v42, 0xffff0000, v42
    v_add_f32 v40, v40, v43
    v_mfma_f32_16x16x32_bf16 v[140:143], v[192:195], v[172:175], v[140:143]
    s_waitcnt lgkmcnt(0)
    v_mfma_f32_16x16x32_bf16 v[96:99], v[224:227], v[200:203], v[96:99]
    v_add_f32 v41, v41, v42
    v_lshlrev_b32 v42, 16, v247
    v_and_b32 v43, 0xffff0000, v247
    ds_read_b128 v[160:163], v5 offset:0
    v_mfma_f32_16x16x32_bf16 v[100:103], v[224:227], v[204:207], v[100:103]
    v_lshlrev_b32 v44, 16, v255
    v_and_b32 v45, 0xffff0000, v255
    v_mul_f32 v42, v42, v44
    ds_read_b128 v[176:179], v10 offset:0
    v_mfma_f32_16x16x32_bf16 v[104:107], v[224:227], v[208:211], v[104:107]
    v_mul_f32 v43, v43, v45
    v_cvt_pk_bf16_f32 v42, v42, v43
    v_lshlrev_b32 v43, 16, v42
    ds_read_b128 v[164:167], v5 offset:2048
    v_mfma_f32_16x16x32_bf16 v[108:111], v[224:227], v[212:215], v[108:111]
    v_and_b32 v42, 0xffff0000, v42
    v_add_f32 v40, v40, v43
    v_add_f32 v41, v41, v42
    ds_read_b128 v[168:171], v5 offset:4096
    v_mfma_f32_16x16x32_bf16 v[112:115], v[228:231], v[200:203], v[112:115]
    v_add_f32 v40, v40, v41
    s_nop 1
    v_add_f32_dpp v40, v40, v40 row_shr:1 row_mask:0xf bank_mask:0xf
    s_nop 1
    v_add_f32_dpp v40, v40, v40 row_shr:2 row_mask:0xf bank_mask:0xf
    ds_read_b128 v[172:175], v5 offset:6144
    v_mfma_f32_16x16x32_bf16 v[116:119], v[228:231], v[204:207], v[116:119]
    v_add_f32_dpp v40, v40, v40 row_shr:4 row_mask:0xf bank_mask:0xf
    s_nop 1
    v_add_f32_dpp v40, v40, v40 row_shr:8 row_mask:0xf bank_mask:0xf
    s_nop 1
    v_add_f32_dpp v40, v40, v40 row_bcast:15 row_mask:0xa bank_mask:0xf
    ds_read_b128 v[180:183], v10 offset:2048
    v_mfma_f32_16x16x32_bf16 v[120:123], v[228:231], v[208:211], v[120:123]
    v_add_f32_dpp v40, v40, v40 row_bcast:31 row_mask:0xc bank_mask:0xf
    s_nop 0
    v_readlane_b32 s85, v40, 63
    s_nop 1
    v_mov_b32 v40, s85
    v_mfma_f32_16x16x32_bf16 v[124:127], v[228:231], v[212:215], v[124:127]
    v_cvt_pk_bf16_f32 v40, v40, v40
    v_lshlrev_b32 v40, 16, v40
    v_mul_f32 v40, 3216550459, v40
    v_mfma_f32_16x16x32_bf16 v[128:131], v[232:235], v[200:203], v[128:131]
    v_exp_f32 v40, v40
    s_nop 0
    v_add_f32 v40, 1.0, v40
    v_rcp_f32 v40, v40
    v_mfma_f32_16x16x32_bf16 v[132:135], v[232:235], v[204:207], v[132:135]
    v_cvt_pk_bf16_f32 v40, v40, v40
    v_lshlrev_b32 v40, 16, v40
    s_lshl_b32 s85, s87, 2
    v_mfma_f32_16x16x32_bf16 v[136:139], v[232:235], v[208:211], v[136:139]
    s_add_u32 s85, s85, 23068672
    v_mov_b32 v41, 0
    buffer_store_dword v40, v41, s[16:19], s85 offen sc1
    v_mfma_f32_16x16x32_bf16 v[140:143], v[232:235], v[212:215], v[140:143]
    s_add_u32 s20, s62, 23134208
    s_addc_u32 s21, s63, 0
    s_mov_b32 s22, 131072
    s_mov_b32 s23, 0x00020000
    s_lshr_b32 s69, s68, 3
    s_and_b32 s78, s68, 7
    v_and_b32 v32, 15, v0
    s_sub_u32 s80, s67, 7
    s_lshl_b32 s80, s80, 14
    s_lshl_b32 s84, s68, 9
    s_add_u32 s80, s80, s84
    s_add_u32 s80, s80, 256
    v_lshlrev_b32 v27, 4, v32
    v_lshrrev_b32 v44, 4, v0
    v_lshl_add_u32 v27, v44, 14, v27
    v_add_u32 v27, s80, v27
    v_add_u32 v252, 0x10000, v27
    v_mov_b32 v45, 0x80000000
    v_cmp_eq_u32 vcc, 3, v44
    s_nop 1
    v_cndmask_b32 v252, v252, v45, vcc
    v_cmp_gt_u32 vcc, 0x20000, v27
    s_nop 1
    v_cndmask_b32 v253, 0, -1, vcc
    v_cmp_gt_u32 vcc, 0x20000, v252
    s_nop 1
    v_cndmask_b32 v254, 0, -1, vcc
    s_lshl_b32 s80, s67, 5
    s_lshl_b32 s84, s69, 3
    s_add_u32 s80, s80, s84
    s_lshl_b32 s80, s80, 7
    s_add_u32 s70, s80, 23658496
    v_and_b32 v30, 7, v0
    s_cmp_lt_u32 s78, 2
    s_cselect_b32 s84, 8, s78
    v_cmp_ne_u32 vcc, s84, v30
    s_nop 1
    v_cndmask_b32 v43, 0, -1, vcc
    v_lshlrev_b32 v30, 7, v30
    buffer_load_dwordx4 v[240:243], v27, s[20:23], 0 offen sc1
    buffer_load_dwordx4 v[244:247], v252, s[20:23], 0 offen sc1
    buffer_load_dword v31, v30, s[16:19], s70 offen sc1
    s_waitcnt lgkmcnt(0)
    v_mfma_f32_16x16x32_bf16 v[64:67], v[160:163], v[176:179], v[64:67]
    ds_read_b128 v[200:203], v6 offset:0
    v_mfma_f32_16x16x32_bf16 v[68:71], v[164:167], v[176:179], v[68:71]
    ds_read_b128 v[216:219], v11 offset:0
    v_mfma_f32_16x16x32_bf16 v[72:75], v[168:171], v[176:179], v[72:75]
    ds_read_b128 v[204:207], v6 offset:2048
    s_lshr_b32 s71, s81, 1
    s_lshl_b32 s71, s71, 15
    s_and_b32 s72, s81, 1
    s_lshl_b32 s72, s72, 10
    s_add_u32 s71, s71, s72
    s_add_u32 s92, s71, s83
    s_add_u32 s81, s81, 1
    v_cvt_pk_bf16_f32 v184, v96, v97
    v_cvt_pk_bf16_f32 v185, v98, v99
    v_cvt_pk_bf16_f32 v186, v112, v113
    v_cvt_pk_bf16_f32 v187, v114, v115
    v_pk_max_i16 v184, v184, 0
    v_pk_max_i16 v185, v185, 0
    v_pk_max_i16 v186, v186, 0
    v_pk_max_i16 v187, v187, 0
    buffer_store_dwordx4 v[184:187], v1, s[16:19], s92 offen offset:0 sc1
    v_mfma_f32_16x16x32_bf16 v[76:79], v[172:175], v[176:179], v[76:79]
    ds_read_b128 v[208:211], v6 offset:4096
    v_mfma_f32_16x16x32_bf16 v[80:83], v[160:163], v[180:183], v[80:83]
    ds_read_b128 v[212:215], v6 offset:6144
    v_mfma_f32_16x16x32_bf16 v[84:87], v[164:167], v[180:183], v[84:87]
    ds_read_b128 v[220:223], v11 offset:2048
    v_mfma_f32_16x16x32_bf16 v[88:91], v[168:171], v[180:183], v[88:91]
    v_cvt_pk_bf16_f32 v188, v100, v101
    v_cvt_pk_bf16_f32 v189, v102, v103
    v_cvt_pk_bf16_f32 v190, v116, v117
    v_cvt_pk_bf16_f32 v191, v118, v119
    v_pk_max_i16 v188, v188, 0
    v_pk_max_i16 v189, v189, 0
    v_pk_max_i16 v190, v190, 0
    v_pk_max_i16 v191, v191, 0
    buffer_store_dwordx4 v[188:191], v1, s[16:19], s92 offen offset:2048 sc1
    v_mfma_f32_16x16x32_bf16 v[92:95], v[172:175], v[180:183], v[92:95]
    s_waitcnt lgkmcnt(0)
    v_mfma_f32_16x16x32_bf16 v[64:67], v[200:203], v[216:219], v[64:67]
    ds_read_b128 v[160:163], v50 offset:0
    v_mfma_f32_16x16x32_bf16 v[68:71], v[204:207], v[216:219], v[68:71]
    ds_read_b128 v[176:179], v52 offset:0
    v_mfma_f32_16x16x32_bf16 v[72:75], v[208:211], v[216:219], v[72:75]
    ds_read_b128 v[164:167], v50 offset:2048
    v_cvt_pk_bf16_f32 v192, v104, v105
    v_cvt_pk_bf16_f32 v193, v106, v107
    v_cvt_pk_bf16_f32 v194, v120, v121
    v_cvt_pk_bf16_f32 v195, v122, v123
    v_pk_max_i16 v192, v192, 0
    v_pk_max_i16 v193, v193, 0
    v_pk_max_i16 v194, v194, 0
    v_pk_max_i16 v195, v195, 0
    buffer_store_dwordx4 v[192:195], v2, s[16:19], s92 offen offset:0 sc1
    v_mfma_f32_16x16x32_bf16 v[76:79], v[212:215], v[216:219], v[76:79]
    ds_read_b128 v[168:171], v50 offset:4096
    v_mfma_f32_16x16x32_bf16 v[80:83], v[200:203], v[220:223], v[80:83]
    ds_read_b128 v[172:175], v50 offset:6144
    v_mfma_f32_16x16x32_bf16 v[84:87], v[204:207], v[220:223], v[84:87]
    ds_read_b128 v[180:183], v52 offset:2048
    v_mfma_f32_16x16x32_bf16 v[88:91], v[208:211], v[220:223], v[88:91]
    v_cvt_pk_bf16_f32 v196, v108, v109
    v_cvt_pk_bf16_f32 v197, v110, v111
    v_cvt_pk_bf16_f32 v198, v124, v125
    v_cvt_pk_bf16_f32 v199, v126, v127
    v_pk_max_i16 v196, v196, 0
    v_pk_max_i16 v197, v197, 0
    v_pk_max_i16 v198, v198, 0
    v_pk_max_i16 v199, v199, 0
    buffer_store_dwordx4 v[196:199], v2, s[16:19], s92 offen offset:2048 sc1
    v_mfma_f32_16x16x32_bf16 v[92:95], v[212:215], v[220:223], v[92:95]
    s_waitcnt lgkmcnt(0)
    v_mfma_f32_16x16x32_bf16 v[64:67], v[160:163], v[176:179], v[64:67]
    ds_read_b128 v[200:203], v51 offset:0
    v_mfma_f32_16x16x32_bf16 v[68:71], v[164:167], v[176:179], v[68:71]
    ds_read_b128 v[216:219], v53 offset:0
    v_mfma_f32_16x16x32_bf16 v[72:75], v[168:171], v[176:179], v[72:75]
    ds_read_b128 v[204:207], v51 offset:2048
    s_lshr_b32 s71, s82, 1
    s_lshl_b32 s71, s71, 15
    s_and_b32 s72, s82, 1
    s_lshl_b32 s72, s72, 10
    s_add_u32 s71, s71, s72
    s_add_u32 s92, s71, s83
    v_cvt_pk_bf16_f32 v224, v128, v129
    v_cvt_pk_bf16_f32 v225, v130, v131
    v_pk_max_i16 v224, v224, 0
    v_pk_max_i16 v225, v225, 0
    buffer_store_dwordx2 v[224:225], v3, s[16:19], s92 offen offset:0 sc1
    v_mfma_f32_16x16x32_bf16 v[76:79], v[172:175], v[176:179], v[76:79]
    ds_read_b128 v[208:211], v51 offset:4096
    v_mfma_f32_16x16x32_bf16 v[80:83], v[160:163], v[180:183], v[80:83]
    ds_read_b128 v[212:215], v51 offset:6144
    v_mfma_f32_16x16x32_bf16 v[84:87], v[164:167], v[180:183], v[84:87]
    ds_read_b128 v[220:223], v53 offset:2048
    v_mfma_f32_16x16x32_bf16 v[88:91], v[168:171], v[180:183], v[88:91]
    v_cvt_pk_bf16_f32 v228, v132, v133
    v_cvt_pk_bf16_f32 v229, v134, v135
    v_pk_max_i16 v228, v228, 0
    v_pk_max_i16 v229, v229, 0
    buffer_store_dwordx2 v[228:229], v3, s[16:19], s92 offen offset:2048 sc1
    v_mfma_f32_16x16x32_bf16 v[92:95], v[172:175], v[180:183], v[92:95]
    s_waitcnt lgkmcnt(0)
    v_mfma_f32_16x16x32_bf16 v[64:67], v[200:203], v[216:219], v[64:67]
    v_mfma_f32_16x16x32_bf16 v[68:71], v[204:207], v[216:219], v[68:71]
    v_mfma_f32_16x16x32_bf16 v[72:75], v[208:211], v[216:219], v[72:75]
    v_cvt_pk_bf16_f32 v232, v136, v137
    v_cvt_pk_bf16_f32 v233, v138, v139
    v_pk_max_i16 v232, v232, 0
    v_pk_max_i16 v233, v233, 0
    buffer_store_dwordx2 v[232:233], v4, s[16:19], s92 offen offset:0 sc1
    v_mfma_f32_16x16x32_bf16 v[76:79], v[212:215], v[216:219], v[76:79]
    v_mfma_f32_16x16x32_bf16 v[80:83], v[200:203], v[220:223], v[80:83]
    v_mfma_f32_16x16x32_bf16 v[84:87], v[204:207], v[220:223], v[84:87]
    v_mfma_f32_16x16x32_bf16 v[88:91], v[208:211], v[220:223], v[88:91]
    v_cvt_pk_bf16_f32 v236, v140, v141
    v_cvt_pk_bf16_f32 v237, v142, v143
    v_pk_max_i16 v236, v236, 0
    v_pk_max_i16 v237, v237, 0
    buffer_store_dwordx2 v[236:237], v4, s[16:19], s92 offen offset:2048 sc1
    v_mfma_f32_16x16x32_bf16 v[92:95], v[212:215], v[220:223], v[92:95]
    v_lshlrev_b32 v46, 3, v0
    s_lshl_b32 s84, s64, 9
    s_add_u32 s84, s84, 153600
    v_add_u32 v46, s84, v46
    v_mov_b32 v36, 0
    v_mov_b32 v37, 0
    ds_write_b64 v46, v[36:37]
    v_fmac_f32 v65, v14, v64
    v_fmac_f32 v81, v14, v80
    v_fma_f32 v65, -v15, v80, v65
    v_fmac_f32 v81, v15, v64
    v_fmac_f32 v66, v14, v65
    v_fmac_f32 v82, v14, v81
    v_fma_f32 v66, -v15, v81, v66
    v_fmac_f32 v82, v15, v65
    v_fmac_f32 v67, v14, v66
    v_fmac_f32 v83, v14, v82
    v_fma_f32 v67, -v15, v82, v67
    v_fmac_f32 v83, v15, v66
    v_fmac_f32 v68, v14, v67
    v_fmac_f32 v84, v14, v83
    v_fma_f32 v68, -v15, v83, v68
    v_fmac_f32 v84, v15, v67
    v_fmac_f32 v69, v14, v68
    v_fmac_f32 v85, v14, v84
    v_fma_f32 v69, -v15, v84, v69
    v_fmac_f32 v85, v15, v68
    v_fmac_f32 v70, v14, v69
    v_fmac_f32 v86, v14, v85
    v_fma_f32 v70, -v15, v85, v70
    v_fmac_f32 v86, v15, v69
    v_fmac_f32 v71, v14, v70
    v_fmac_f32 v87, v14, v86
    v_fma_f32 v71, -v15, v86, v71
    v_fmac_f32 v87, v15, v70
    v_fmac_f32 v72, v14, v71
    v_fmac_f32 v88, v14, v87
    v_fma_f32 v72, -v15, v87, v72
    v_fmac_f32 v88, v15, v71
    v_fmac_f32 v73, v14, v72
    v_fmac_f32 v89, v14, v88
    v_fma_f32 v73, -v15, v88, v73
    v_fmac_f32 v89, v15, v72
    v_fmac_f32 v74, v14, v73
    v_fmac_f32 v90, v14, v89
    v_fma_f32 v74, -v15, v89, v74
    v_fmac_f32 v90, v15, v73
    v_fmac_f32 v75, v14, v74
    v_fmac_f32 v91, v14, v90
    v_fma_f32 v75, -v15, v90, v75
    v_fmac_f32 v91, v15, v74
    v_fmac_f32 v76, v14, v75
    v_fmac_f32 v92, v14, v91
    v_fma_f32 v76, -v15, v91, v76
    v_fmac_f32 v92, v15, v75
    v_fmac_f32 v77, v14, v76
    v_fmac_f32 v93, v14, v92
    v_fma_f32 v77, -v15, v92, v77
    v_fmac_f32 v93, v15, v76
    v_fmac_f32 v78, v14, v77
    v_fmac_f32 v94, v14, v93
    v_fma_f32 v78, -v15, v93, v78
    v_fmac_f32 v94, v15, v77
    v_fmac_f32 v79, v14, v78
    v_fmac_f32 v95, v14, v94
    v_fma_f32 v79, -v15, v94, v79
    v_fmac_f32 v95, v15, v78
    v_lshlrev_b32 v46, 8, v26
    v_lshl_add_u32 v46, v32, 3, v46
    v_mov_b32 v36, v79
    v_mov_b32 v37, v95
    v_add_u32 v38, 153984, v46
    v_add_u32 v46, 157824, v46
    ds_write_b64 v46, v[36:37]
    s_waitcnt vmcnt(12)
k1_np1:
    v_readfirstlane_b32 s100, v48
    s_nop 0
    s_cmp_lg_u32 s100, 0
    s_cbranch_scc1 k1_nq1
    s_sleep 4
    buffer_load_dword v48, v33, s[28:31], 0 offen sc1
    s_waitcnt vmcnt(0)
    s_branch k1_np1
k1_nq1:
    s_waitcnt lgkmcnt(0)
    s_barrier
    ds_read_b64 v[160:161], v38 offset:0
    ds_read_b64 v[162:163], v38 offset:256
    ds_read_b64 v[164:165], v38 offset:512
    ds_read_b64 v[166:167], v38 offset:768
    ds_read_b64 v[168:169], v38 offset:1024
    ds_read_b64 v[170:171], v38 offset:1280
    ds_read_b64 v[172:173], v38 offset:1536
    ds_read_b64 v[174:175], v38 offset:1792
    ds_read_b64 v[176:177], v38 offset:2048
    ds_read_b64 v[178:179], v38 offset:2304
    ds_read_b64 v[180:181], v38 offset:2560
    ds_read_b64 v[182:183], v38 offset:2816
    ds_read_b64 v[184:185], v38 offset:3072
    ds_read_b64 v[186:187], v38 offset:3328
    ds_read_b64 v[188:189], v38 offset:3584
    v_mov_b32 v44, 161792
    v_mov_b32 v45, 1
    s_mov_b64 exec, 1
    s_waitcnt vmcnt(0)
    ds_add_rtn_u32 v46, v44, v45
    s_lshl_b32 s80, s67, 5
    s_add_u32 s80, s80, s68
    s_lshl_b32 s101, s80, 7
    s_add_u32 s80, s101, 23658496
    v_mov_b32 v44, 0
    v_mov_b32 v45, s100
    s_waitcnt lgkmcnt(0)
    v_readfirstlane_b32 s81, v46
    s_nop 0
    s_cmp_lg_u32 s81, 7
    s_cbranch_scc1 k1_nosig1
    buffer_store_dword v45, v44, s[16:19], s80 offen sc1
k1_nosig1:
    s_mov_b64 exec, -1
    s_mul_i32 s71, s78, 112
    s_add_u32 s71, s71, 175
    s_lshr_b32 s71, s71, 6
    s_mov_b32 s71, 0
    s_cmp_eq_u32 s71, 14
    s_cselect_b32 s85, 0, s71
    s_add_u32 s86, s85, 1
    s_cmp_eq_u32 s86, 14
    s_cselect_b32 s86, 0, s86
    s_add_u32 s87, s86, 1
    s_cmp_eq_u32 s87, 14
    s_cselect_b32 s87, 0, s87
    s_add_u32 s71, s87, 1
    s_cmp_eq_u32 s71, 14
    s_cselect_b32 s71, 0, s71
    s_mul_i32 s79, s69, 1835008
    s_lshl_b32 s97, s69, 9
    s_sub_u32 s97, s97, 896
    v_lshrrev_b32 v7, 3, v0
    v_and_b32 v8, 7, v0
    v_and_b32 v9, 15, v0
    v_lshrrev_b32 v10, 4, v0
    s_lshl_b32 s80, s64, 3
    v_add_u32 v12, s80, v10
    v_lshlrev_b32 v12, 11, v12
    s_lshl_b32 s80, s78, 8
    v_add_u32 v12, s80, v12
    v_lshlrev_b32 v13, 1, v10
    v_xor_b32 v13, v13, v9
    v_lshl_add_u32 v3, v13, 4, v12
    v_xor_b32 v4, 128, v3
    v_add_u32 v4, 0x2000, v4
    s_lshl_b32 s93, s64, 12
    s_add_u32 s94, s93, 2048
    s_lshl_b32 s95, s64, 11
    s_add_u32 s95, s95, 32768
    s_add_u32 s96, s95, 1024
    s_mov_b32 s8, s54
    s_mov_b32 s9, s55
    s_mov_b32 s10, 7340032
    s_mov_b32 s11, 0x00020000
    s_mov_b32 s4, s62
    s_mov_b32 s5, s63
    s_mov_b32 s6, 23068672
    s_mov_b32 s7, 0x00020000
    s_lshl_b32 s74, s85, 17
    s_add_u32 m0, s95, 0
    s_add_u32 s74, s74, s79
    buffer_load_dwordx4 v3, s[8:11], s74 offen lds
    s_lshl_b32 s74, s85, 17
    s_add_u32 m0, s96, 0
    s_add_u32 s74, s74, s79
    buffer_load_dwordx4 v4, s[8:11], s74 offen lds
    s_lshl_b32 s74, s86, 17
    s_add_u32 m0, s95, 49152
    s_add_u32 s74, s74, s79
    buffer_load_dwordx4 v3, s[8:11], s74 offen lds
    s_lshl_b32 s74, s86, 17
    s_add_u32 m0, s96, 49152
    s_add_u32 s74, s74, s79
    buffer_load_dwordx4 v4, s[8:11], s74 offen lds
    s_lshl_b32 s74, s87, 17
    s_add_u32 m0, s95, 98304
    s_add_u32 s74, s74, s79
    buffer_load_dwordx4 v3, s[8:11], s74 offen lds
    s_lshl_b32 s74, s87, 17
    s_add_u32 m0, s96, 98304
    s_add_u32 s74, s74, s79
    buffer_load_dwordx4 v4, s[8:11], s74 offen lds
    v_lshlrev_b32 v11, 4, v0
    s_lshr_b32 s80, s64, 1
    s_lshl_b32 s80, s80, 2
    s_and_b32 s81, s64, 1
    s_lshl_b32 s81, s81, 1
    s_add_u32 s81, s81, s69
    s_and_b32 s82, s81, 3
    s_add_u32 s82, s82, s80
    s_lshl_b32 s82, s82, 11
    v_add_u32 v1, s82, v11
    s_add_u32 s81, s81, 1
    s_and_b32 s82, s81, 3
    s_add_u32 s82, s82, s80
    s_lshl_b32 s82, s82, 11
    v_add_u32 v2, s82, v11
    s_lshl_b32 s80, s78, 7
    s_lshl_b32 s81, s64, 4
    s_add_u32 s80, s80, s81
    v_add_u32 v12, s80, v7
    v_lshlrev_b32 v12, 11, v12
    v_lshrrev_b32 v13, 1, v7
    v_xor_b32 v13, v13, v8
    v_lshl_add_u32 v5, v13, 4, v12
    v_xor_b32 v6, 64, v5
    v_add_u32 v6, 0x4000, v6
    s_mul_i32 s73, s67, 88
    s_mul_i32 s80, s69, 14
    s_add_u32 s73, s73, s80
    s_add_u32 s73, s73, 32
    s_lshl_b32 s90, s73, 15
    s_mov_b32 s72, 3
    s_mov_b32 s75, 0
    s_mov_b32 s76, 49152
    v_xor_b32 v44, s100, v242
    v_xor_b32 v45, s100, v246
    v_and_b32 v44, v44, v253
    v_and_or_b32 v44, v45, v254, v44
    v_cmp_ne_u32 vcc, 0, v44
    s_nop 3
    s_cmp_eq_u64 vcc, 0
    s_cselect_b32 s77, 1, 0
    s_mov_b32 s82, 0
    v_xor_b32 v31, s100, v31
    v_and_b32 v31, v31, v43
    v_cmp_ne_u32 vcc, 0, v31
    s_nop 3
    s_cbranch_vccnz k1_slow1
    s_mov_b32 s82, 1
    s_lshl_b32 s73, s85, 15
    s_add_u32 s73, s73, s90
    s_add_u32 m0, s93, 0
    s_nop 0
    buffer_load_dwordx4 v1, s[4:7], s73 offen sc1 lds
    buffer_load_dwordx4 v1, s[4:7], s73 offen offset:1024 sc1 lds
    s_add_u32 m0, s94, 0
    s_nop 0
    buffer_load_dwordx4 v2, s[4:7], s73 offen sc1 lds
    buffer_load_dwordx4 v2, s[4:7], s73 offen offset:1024 sc1 lds
    s_lshl_b32 s73, s86, 15
    s_add_u32 s73, s73, s90
    s_add_u32 m0, s93, 49152
    s_nop 0
    buffer_load_dwordx4 v1, s[4:7], s73 offen sc1 lds
    buffer_load_dwordx4 v1, s[4:7], s73 offen offset:1024 sc1 lds
    s_add_u32 m0, s94, 49152
    s_nop 0
    buffer_load_dwordx4 v2, s[4:7], s73 offen sc1 lds
    buffer_load_dwordx4 v2, s[4:7], s73 offen offset:1024 sc1 lds
k1_slow1:
    s_cmp_eq_u32 s77, 1
    s_cbranch_scc1 k1_ag11
    buffer_load_dwordx4 v[240:243], v27, s[20:23], 0 offen sc1
    buffer_load_dwordx4 v[244:247], v252, s[20:23], 0 offen sc1
k1_ag11:
    v_fmac_f32 v162, v16, v160
    v_fmac_f32 v163, v16, v161
    v_fma_f32 v162, -v17, v161, v162
    v_fmac_f32 v163, v17, v160
    v_fmac_f32 v164, v16, v162
    v_fmac_f32 v165, v16, v163
    v_fma_f32 v164, -v17, v163, v164
    v_fmac_f32 v165, v17, v162
    v_fmac_f32 v166, v16, v164
    v_fmac_f32 v167, v16, v165
    v_fma_f32 v166, -v17, v165, v166
    v_fmac_f32 v167, v17, v164
    v_fmac_f32 v168, v16, v166
    v_fmac_f32 v169, v16, v167
    v_fma_f32 v168, -v17, v167, v168
    v_fmac_f32 v169, v17, v166
    v_fmac_f32 v170, v16, v168
    v_fmac_f32 v171, v16, v169
    v_fma_f32 v170, -v17, v169, v170
    v_fmac_f32 v171, v17, v168
    v_fmac_f32 v172, v16, v170
    v_fmac_f32 v173, v16, v171
    v_fma_f32 v172, -v17, v171, v172
    v_fmac_f32 v173, v17, v170
    v_fmac_f32 v174, v16, v172
    v_fmac_f32 v175, v16, v173
    v_fma_f32 v174, -v17, v173, v174
    v_fmac_f32 v175, v17, v172
    v_fmac_f32 v176, v16, v174
    v_fmac_f32 v177, v16, v175
    v_fma_f32 v176, -v17, v175, v176
    v_fmac_f32 v177, v17, v174
    v_fmac_f32 v178, v16, v176
    v_fmac_f32 v179, v16, v177
    v_fma_f32 v178, -v17, v177, v178
    v_fmac_f32 v179, v17, v176
    v_fmac_f32 v180, v16, v178
    v_fmac_f32 v181, v16, v179
    v_fma_f32 v180, -v17, v179, v180
    v_fmac_f32 v181, v17, v178
    v_fmac_f32 v182, v16, v180
    v_fmac_f32 v183, v16, v181
    v_fma_f32 v182, -v17, v181, v182
    v_fmac_f32 v183, v17, v180
    v_fmac_f32 v184, v16, v182
    v_fmac_f32 v185, v16, v183
    v_fma_f32 v184, -v17, v183, v184
    v_fmac_f32 v185, v17, v182
    v_fmac_f32 v186, v16, v184
    v_fmac_f32 v187, v16, v185
    v_fma_f32 v186, -v17, v185, v186
    v_fmac_f32 v187, v17, v184
    v_fmac_f32 v188, v16, v186
    v_fmac_f32 v189, v16, v187
    v_fma_f32 v188, -v17, v187, v188
    v_fmac_f32 v189, v17, v186
    v_mov_b32 v28, v188
    v_mov_b32 v29, v189
    v_mul_f32 v44, v22, v64
    v_mul_f32 v45, v23, v64
    v_fma_f32 v64, -v23, v80, v44
    v_fma_f32 v80, -v22, v80, -v45
    v_mul_f32 v44, v22, v65
    v_mul_f32 v45, v23, v65
    v_fma_f32 v65, -v23, v81, v44
    v_fma_f32 v81, -v22, v81, -v45
    v_mul_f32 v44, v22, v66
    v_mul_f32 v45, v23, v66
    v_fma_f32 v66, -v23, v82, v44
    v_fma_f32 v82, -v22, v82, -v45
    v_mul_f32 v44, v22, v67
    v_mul_f32 v45, v23, v67
    v_fma_f32 v67, -v23, v83, v44
    v_fma_f32 v83, -v22, v83, -v45
    v_mul_f32 v44, v22, v68
    v_mul_f32 v45, v23, v68
    v_fma_f32 v68, -v23, v84, v44
    v_fma_f32 v84, -v22, v84, -v45
    v_mul_f32 v44, v22, v69
    v_mul_f32 v45, v23, v69
    v_fma_f32 v69, -v23, v85, v44
    v_fma_f32 v85, -v22, v85, -v45
    v_mul_f32 v44, v22, v70
    v_mul_f32 v45, v23, v70
    v_fma_f32 v70, -v23, v86, v44
    v_fma_f32 v86, -v22, v86, -v45
    v_mul_f32 v44, v22, v71
    v_mul_f32 v45, v23, v71
    v_fma_f32 v71, -v23, v87, v44
    v_fma_f32 v87, -v22, v87, -v45
    v_mul_f32 v44, v22, v72
    v_mul_f32 v45, v23, v72
    v_fma_f32 v72, -v23, v88, v44
    v_fma_f32 v88, -v22, v88, -v45
    v_mul_f32 v44, v22, v73
    v_mul_f32 v45, v23, v73
    v_fma_f32 v73, -v23, v89, v44
    v_fma_f32 v89, -v22, v89, -v45
    v_mul_f32 v44, v22, v74
    v_mul_f32 v45, v23, v74
    v_fma_f32 v74, -v23, v90, v44
    v_fma_f32 v90, -v22, v90, -v45
    v_mul_f32 v44, v22, v75
    v_mul_f32 v45, v23, v75
    v_fma_f32 v75, -v23, v91, v44
    v_fma_f32 v91, -v22, v91, -v45
    v_mul_f32 v44, v22, v76
    v_mul_f32 v45, v23, v76
    v_fma_f32 v76, -v23, v92, v44
    v_fma_f32 v92, -v22, v92, -v45
    v_mul_f32 v44, v22, v77
    v_mul_f32 v45, v23, v77
    v_fma_f32 v77, -v23, v93, v44
    v_fma_f32 v93, -v22, v93, -v45
    v_mul_f32 v44, v22, v78
    v_mul_f32 v45, v23, v78
    v_fma_f32 v78, -v23, v94, v44
    v_fma_f32 v94, -v22, v94, -v45
    v_mul_f32 v44, v22, v79
    v_mul_f32 v45, v23, v79
    v_fma_f32 v79, -v23, v95, v44
    v_fma_f32 v95, -v22, v95, -v45
    s_cmp_eq_u32 s82, 1
    s_cbranch_scc1 k1_hf11
    buffer_load_dword v31, v30, s[16:19], s70 offen sc1
k1_hf11:
    v_mov_b32 v160, v14
    v_mov_b32 v161, v15
    v_mul_f32 v162, v14, v160
    v_mul_f32 v163, v14, v161
    v_fma_f32 v162, -v15, v161, v162
    v_fmac_f32 v163, v15, v160
    v_mul_f32 v164, v14, v162
    v_mul_f32 v165, v14, v163
    v_fma_f32 v164, -v15, v163, v164
    v_fmac_f32 v165, v15, v162
    v_mul_f32 v166, v14, v164
    v_mul_f32 v167, v14, v165
    v_fma_f32 v166, -v15, v165, v166
    v_fmac_f32 v167, v15, v164
    v_mul_f32 v168, v14, v166
    v_mul_f32 v169, v14, v167
    v_fma_f32 v168, -v15, v167, v168
    v_fmac_f32 v169, v15, v166
    v_mul_f32 v170, v14, v168
    v_mul_f32 v171, v14, v169
    v_fma_f32 v170, -v15, v169, v170
    v_fmac_f32 v171, v15, v168
    v_mul_f32 v172, v14, v170
    v_mul_f32 v173, v14, v171
    v_fma_f32 v172, -v15, v171, v172
    v_fmac_f32 v173, v15, v170
    v_mul_f32 v174, v14, v172
    v_mul_f32 v175, v14, v173
    v_fma_f32 v174, -v15, v173, v174
    v_fmac_f32 v175, v15, v172
    v_mul_f32 v176, v14, v174
    v_mul_f32 v177, v14, v175
    v_fma_f32 v176, -v15, v175, v176
    v_fmac_f32 v177, v15, v174
    v_mul_f32 v178, v14, v176
    v_mul_f32 v179, v14, v177
    v_fma_f32 v178, -v15, v177, v178
    v_fmac_f32 v179, v15, v176
    v_mul_f32 v180, v14, v178
    v_mul_f32 v181, v14, v179
    v_fma_f32 v180, -v15, v179, v180
    v_fmac_f32 v181, v15, v178
    v_mul_f32 v182, v14, v180
    v_mul_f32 v183, v14, v181
    v_fma_f32 v182, -v15, v181, v182
    v_fmac_f32 v183, v15, v180
    v_mul_f32 v184, v14, v182
    v_mul_f32 v185, v14, v183
    v_fma_f32 v184, -v15, v183, v184
    v_fmac_f32 v185, v15, v182
    v_mul_f32 v186, v14, v184
    v_mul_f32 v187, v14, v185
    v_fma_f32 v186, -v15, v185, v186
    v_fmac_f32 v187, v15, v184
    v_mul_f32 v188, v14, v186
    v_mul_f32 v189, v14, v187
    v_fma_f32 v188, -v15, v187, v188
    v_fmac_f32 v189, v15, v186
    v_mul_f32 v190, v14, v188
    v_mul_f32 v191, v14, v189
    v_fma_f32 v190, -v15, v189, v190
    v_fmac_f32 v191, v15, v188
    v_and_b32 v50, 15, v0
    v_lshrrev_b32 v51, 4, v0
    v_lshlrev_b32 v52, 4, v0
    v_bfe_u32 v53, v0, 2, 2
    v_and_b32 v54, 3, v0
    v_lshl_add_u32 v55, v51, 3, v53
    v_and_b32 v46, 1, v54
    v_lshlrev_b32 v46, 2, v46
    v_lshrrev_b32 v47, 1, v54
    v_lshl_or_b32 v46, v47, 4, v46
    v_xor_b32 v55, v55, v46
    v_lshl_add_u32 v55, v54, 5, v55
    v_lshlrev_b32 v55, 3, v55
    s_lshl_b32 s80, s65, 13
    v_add_u32 v7, s80, v55
    v_xor_b32 v8, 32, v7
    v_add_u32 v11, s80, v52
    v_lshrrev_b32 v55, 1, v50
    v_xor_b32 v55, v55, v51
    v_lshlrev_b32 v55, 4, v55
    v_lshl_add_u32 v55, v50, 7, v55
    s_lshl_b32 s80, s66, 13
    s_add_u32 s80, s80, 32768
    v_add_u32 v9, s80, v55
    v_xor_b32 v10, 64, v9
    v_lshl_add_u32 v55, v51, 2, v53
    v_and_b32 v46, 7, v55
    v_lshlrev_b32 v46, 1, v46
    s_lshl_b32 s80, s66, 3
    v_add_u32 v47, s80, v47
    v_xor_b32 v46, v46, v47
    v_lshlrev_b32 v46, 4, v46
    v_lshl_add_u32 v46, v55, 8, v46
    v_and_b32 v47, 1, v54
    v_lshl_add_u32 v46, v47, 3, v46
    v_add_u32 v12, 32768, v46
    v_xor_b32 v13, 32, v12
    v_xor_b32 v14, 64, v12
    v_xor_b32 v15, 96, v12
    s_mul_i32 s83, s67, 88
    s_and_b32 s84, s68, 30
    s_add_u32 s83, s83, s84
    s_lshl_b32 s83, s83, 15
    s_lshl_b32 s84, s65, 13
    s_add_u32 s83, s83, s84
    s_lshl_b32 s84, s88, 10
    s_add_u32 s83, s83, s84
    s_add_u32 s84, s83, 32768
    v_lshrrev_b32 v33, 4, v0
    v_and_b32 v45, 1, v33
    v_lshlrev_b32 v45, 2, v45
    v_lshrrev_b32 v46, 1, v33
    v_lshl_or_b32 v45, v46, 4, v45
    v_add_u32 v46, 16, v32
    v_xor_b32 v45, v45, v46
    v_lshl_add_u32 v45, v33, 5, v45
    v_lshlrev_b32 v39, 3, v45
    v_add_u32 v40, 4096, v39
    s_cmp_eq_u32 s82, 1
    s_cbranch_scc1 k1_fast1
k1_hp1:
    s_waitcnt vmcnt(0)
    v_xor_b32 v31, s100, v31
    v_and_b32 v31, v31, v43
    v_cmp_ne_u32 vcc, 0, v31
    s_nop 3
    s_cbranch_vccz k1_hq1
    s_sleep 1
    buffer_load_dword v31, v30, s[16:19], s70 offen sc1
    s_branch k1_hp1
k1_hq1:
    s_lshl_b32 s73, s85, 15
    s_add_u32 s73, s73, s90
    s_add_u32 m0, s93, 0
    s_nop 0
    buffer_load_dwordx4 v1, s[4:7], s73 offen sc1 lds
    buffer_load_dwordx4 v1, s[4:7], s73 offen offset:1024 sc1 lds
    s_add_u32 m0, s94, 0
    s_nop 0
    buffer_load_dwordx4 v2, s[4:7], s73 offen sc1 lds
    buffer_load_dwordx4 v2, s[4:7], s73 offen offset:1024 sc1 lds
    s_cmp_eq_u32 s77, 1
    s_cbranch_scc1 k1_adone1
    s_branch k1_agc1
k1_fast1:
    s_cmp_eq_u32 s77, 1
    s_cbranch_scc1 k1_adone1
k1_agw1:
    s_waitcnt vmcnt(0)
k1_agc1:
    v_xor_b32 v44, s100, v242
    v_xor_b32 v45, s100, v246
    v_and_b32 v44, v44, v253
    v_and_or_b32 v44, v45, v254, v44
    v_cmp_ne_u32 vcc, 0, v44
    s_nop 3
    s_cbranch_vccz k1_adone1
    s_sleep 1
    buffer_load_dwordx4 v[240:243], v27, s[20:23], 0 offen sc1
    buffer_load_dwordx4 v[244:247], v252, s[20:23], 0 offen sc1
    s_branch k1_agw1
k1_adone1:
    v_mul_f32 v248, v18, v240
    v_mul_f32 v249, v18, v241
    v_fma_f32 v248, -v19, v241, v248
    v_fmac_f32 v249, v19, v240
    v_fmac_f32 v248, v34, v244
    v_fmac_f32 v249, v34, v245
    v_fma_f32 v248, -v35, v245, v248
    v_fmac_f32 v249, v35, v244
    v_mov_b32 v250, v248
    v_mov_b32 v251, v249
    s_nop 0
    v_permlane32_swap_b32 v248, v250
    v_permlane32_swap_b32 v249, v251
    v_add_f32 v248, v248, v250
    v_add_f32 v249, v249, v251
    v_mov_b32 v250, v248
    v_mov_b32 v251, v249
    s_nop 0
    v_permlane16_swap_b32 v248, v250
    v_permlane16_swap_b32 v249, v251
    v_add_f32 v248, v248, v250
    v_add_f32 v249, v249, v251
    v_fmac_f32 v28, v20, v248
    v_fmac_f32 v29, v20, v249
    v_fma_f32 v28, -v21, v249, v28
    v_fmac_f32 v29, v21, v248
    v_mul_f32 v46, v22, v28
    v_mul_f32 v47, v22, v29
    v_fma_f32 v46, -v23, v29, v46
    v_fmac_f32 v47, v23, v28
    v_fmac_f32 v64, v160, v46
    v_fma_f32 v80, -v160, v47, v80
    v_fma_f32 v64, -v161, v47, v64
    v_fma_f32 v80, -v161, v46, v80
    v_fmac_f32 v65, v162, v46
    v_fma_f32 v81, -v162, v47, v81
    v_fma_f32 v65, -v163, v47, v65
    v_fma_f32 v81, -v163, v46, v81
    v_fmac_f32 v66, v164, v46
    v_fma_f32 v82, -v164, v47, v82
    v_fma_f32 v66, -v165, v47, v66
    v_fma_f32 v82, -v165, v46, v82
    v_fmac_f32 v67, v166, v46
    v_fma_f32 v83, -v166, v47, v83
    v_fma_f32 v67, -v167, v47, v67
    v_fma_f32 v83, -v167, v46, v83
    v_fmac_f32 v68, v168, v46
    v_fma_f32 v84, -v168, v47, v84
    v_fma_f32 v68, -v169, v47, v68
    v_fma_f32 v84, -v169, v46, v84
    v_fmac_f32 v69, v170, v46
    v_fma_f32 v85, -v170, v47, v85
    v_fma_f32 v69, -v171, v47, v69
    v_fma_f32 v85, -v171, v46, v85
    v_fmac_f32 v70, v172, v46
    v_fma_f32 v86, -v172, v47, v86
    v_fma_f32 v70, -v173, v47, v70
    v_fma_f32 v86, -v173, v46, v86
    v_fmac_f32 v71, v174, v46
    v_fma_f32 v87, -v174, v47, v87
    v_fma_f32 v71, -v175, v47, v71
    v_fma_f32 v87, -v175, v46, v87
    v_fmac_f32 v72, v176, v46
    v_fma_f32 v88, -v176, v47, v88
    v_fma_f32 v72, -v177, v47, v72
    v_fma_f32 v88, -v177, v46, v88
    v_fmac_f32 v73, v178, v46
    v_fma_f32 v89, -v178, v47, v89
    v_fma_f32 v73, -v179, v47, v73
    v_fma_f32 v89, -v179, v46, v89
    v_fmac_f32 v74, v180, v46
    v_fma_f32 v90, -v180, v47, v90
    v_fma_f32 v74, -v181, v47, v74
    v_fma_f32 v90, -v181, v46, v90
    v_fmac_f32 v75, v182, v46
    v_fma_f32 v91, -v182, v47, v91
    v_fma_f32 v75, -v183, v47, v75
    v_fma_f32 v91, -v183, v46, v91
    v_fmac_f32 v76, v184, v46
    v_fma_f32 v92, -v184, v47, v92
    v_fma_f32 v76, -v185, v47, v76
    v_fma_f32 v92, -v185, v46, v92
    v_fmac_f32 v77, v186, v46
    v_fma_f32 v93, -v186, v47, v93
    v_fma_f32 v77, -v187, v47, v77
    v_fma_f32 v93, -v187, v46, v93
    v_fmac_f32 v78, v188, v46
    v_fma_f32 v94, -v188, v47, v94
    v_fma_f32 v78, -v189, v47, v78
    v_fma_f32 v94, -v189, v46, v94
    v_fmac_f32 v79, v190, v46
    v_fma_f32 v95, -v190, v47, v95
    v_fma_f32 v79, -v191, v47, v79
    v_fma_f32 v95, -v191, v46, v95
    s_cmp_eq_u32 s82, 1
    s_cbranch_scc1 k2_start
    s_lshl_b32 s73, s86, 15
    s_add_u32 s73, s73, s90
    s_add_u32 m0, s93, 49152
    s_nop 0
    buffer_load_dwordx4 v1, s[4:7], s73 offen sc1 lds
    buffer_load_dwordx4 v1, s[4:7], s73 offen offset:1024 sc1 lds
    s_add_u32 m0, s94, 49152
    s_nop 0
    buffer_load_dwordx4 v2, s[4:7], s73 offen sc1 lds
    buffer_load_dwordx4 v2, s[4:7], s73 offen offset:1024 sc1 lds
k2_start:
    s_mov_b32 s70, 0
    v_and_b32 v23, 15, v0
    v_lshrrev_b32 v24, 4, v0
    v_lshlrev_b32 v25, 4, v0
    v_add_u32 v16, s75, v11
    v_add_u32 v17, s75, v12
    v_add_u32 v18, s75, v13
    v_add_u32 v19, s75, v14
    v_add_u32 v20, s75, v15
    s_waitcnt vmcnt(4)
    s_barrier
    ds_read_b64_tr_b16 v[176:177], v17 offset:0
    ds_read_b64_tr_b16 v[178:179], v17 offset:4096
    ds_read_b128 v[160:163], v16 offset:0
    ds_read_b128 v[164:167], v16 offset:2048
    ds_read_b128 v[168:171], v16 offset:4096
    ds_read_b128 v[172:175], v16 offset:6144
    ds_read_b64_tr_b16 v[180:181], v18 offset:0
    ds_read_b64_tr_b16 v[182:183], v18 offset:4096
    ds_read_b64_tr_b16 v[184:185], v19 offset:0
    ds_read_b64_tr_b16 v[186:187], v19 offset:4096
    ds_read_b64_tr_b16 v[188:189], v20 offset:0
    ds_read_b64_tr_b16 v[190:191], v20 offset:4096
    s_waitcnt lgkmcnt(0)
    v_mfma_f32_16x16x32_bf16 v[96:99], v[176:179], v[160:163], 0
    ds_read_b64_tr_b16 v[208:209], v17 offset:8192
    s_lshl_b32 s73, s87, 15
    s_add_u32 s73, s73, s90
    s_add_u32 m0, s93, 98304
    s_nop 0
    buffer_load_dwordx4 v1, s[4:7], s73 offen sc1 lds
    v_mfma_f32_16x16x32_bf16 v[112:115], v[176:179], v[164:167], 0
    ds_read_b64_tr_b16 v[210:211], v17 offset:12288
    buffer_load_dwordx4 v1, s[4:7], s73 offen offset:1024 sc1 lds
    v_mfma_f32_16x16x32_bf16 v[128:131], v[176:179], v[168:171], 0
    ds_read_b128 v[192:195], v16 offset:1024
    v_mfma_f32_16x16x32_bf16 v[144:147], v[176:179], v[172:175], 0
    ds_read_b128 v[196:199], v16 offset:3072
    s_add_u32 m0, s94, 98304
    s_nop 0
    buffer_load_dwordx4 v2, s[4:7], s73 offen sc1 lds
    v_mfma_f32_16x16x32_bf16 v[100:103], v[180:183], v[160:163], 0
    ds_read_b128 v[200:203], v16 offset:5120
    buffer_load_dwordx4 v2, s[4:7], s73 offen offset:1024 sc1 lds
    v_mfma_f32_16x16x32_bf16 v[116:119], v[180:183], v[164:167], 0
    ds_read_b128 v[204:207], v16 offset:7168
    v_cvt_pk_bf16_f32 v224, v64, v65
    v_cvt_pk_bf16_f32 v225, v66, v67
    buffer_store_dwordx2 v[224:225], v39, s[16:19], s83 offen offset:0 sc1
    v_mfma_f32_16x16x32_bf16 v[132:135], v[180:183], v[168:171], 0
    ds_read_b64_tr_b16 v[212:213], v18 offset:8192
    v_mfma_f32_16x16x32_bf16 v[148:151], v[180:183], v[172:175], 0
    ds_read_b64_tr_b16 v[214:215], v18 offset:12288
    v_cvt_pk_bf16_f32 v226, v80, v81
    v_cvt_pk_bf16_f32 v227, v82, v83
    buffer_store_dwordx2 v[226:227], v39, s[16:19], s84 offen offset:0 sc1
    v_mfma_f32_16x16x32_bf16 v[104:107], v[184:187], v[160:163], 0
    ds_read_b64_tr_b16 v[216:217], v19 offset:8192
    v_cvt_pk_bf16_f32 v228, v68, v69
    v_cvt_pk_bf16_f32 v229, v70, v71
    buffer_store_dwordx2 v[228:229], v39, s[16:19], s83 offen offset:2048 sc1
    v_mfma_f32_16x16x32_bf16 v[120:123], v[184:187], v[164:167], 0
    ds_read_b64_tr_b16 v[218:219], v19 offset:12288
    v_cvt_pk_bf16_f32 v230, v84, v85
    v_cvt_pk_bf16_f32 v231, v86, v87
    buffer_store_dwordx2 v[230:231], v39, s[16:19], s84 offen offset:2048 sc1
    v_mfma_f32_16x16x32_bf16 v[136:139], v[184:187], v[168:171], 0
    ds_read_b64_tr_b16 v[220:221], v20 offset:8192
    v_mfma_f32_16x16x32_bf16 v[152:155], v[184:187], v[172:175], 0
    ds_read_b64_tr_b16 v[222:223], v20 offset:12288
    v_cvt_pk_bf16_f32 v232, v72, v73
    v_cvt_pk_bf16_f32 v233, v74, v75
    buffer_store_dwordx2 v[232:233], v40, s[16:19], s83 offen offset:0 sc1
    v_mfma_f32_16x16x32_bf16 v[108:111], v[188:191], v[160:163], 0
    v_cvt_pk_bf16_f32 v234, v88, v89
    v_cvt_pk_bf16_f32 v235, v90, v91
    buffer_store_dwordx2 v[234:235], v40, s[16:19], s84 offen offset:0 sc1
    v_mfma_f32_16x16x32_bf16 v[124:127], v[188:191], v[164:167], 0
    v_cvt_pk_bf16_f32 v236, v76, v77
    v_cvt_pk_bf16_f32 v237, v78, v79
    buffer_store_dwordx2 v[236:237], v40, s[16:19], s83 offen offset:2048 sc1
    v_mfma_f32_16x16x32_bf16 v[140:143], v[188:191], v[168:171], 0
    v_mfma_f32_16x16x32_bf16 v[156:159], v[188:191], v[172:175], 0
    v_cvt_pk_bf16_f32 v238, v92, v93
    v_cvt_pk_bf16_f32 v239, v94, v95
    buffer_store_dwordx2 v[238:239], v40, s[16:19], s84 offen offset:2048 sc1
    s_waitcnt vmcnt(12) lgkmcnt(0)
    s_barrier
    v_add_u32 v16, s76, v11
    v_add_u32 v17, s76, v12
    v_add_u32 v18, s76, v13
    v_add_u32 v19, s76, v14
    v_add_u32 v20, s76, v15
    v_mfma_f32_16x16x32_bf16 v[96:99], v[208:211], v[192:195], v[96:99]
    ds_read_b64_tr_b16 v[176:177], v17 offset:0
    s_mov_b32 s77, s75
    s_mov_b32 s75, s76
    s_add_u32 s76, s76, 49152
    s_cmp_lt_u32 s76, 147456
    s_cselect_b32 s76, s76, 0
    s_add_u32 s70, s70, 1
    v_mfma_f32_16x16x32_bf16 v[112:115], v[208:211], v[196:199], v[112:115]
    ds_read_b64_tr_b16 v[178:179], v17 offset:4096
    s_lshl_b32 s74, s71, 17
    s_add_u32 s74, s74, s79
    s_lshl_b32 s73, s71, 15
    s_add_u32 s73, s73, s90
    v_mfma_f32_16x16x32_bf16 v[128:131], v[208:211], v[200:203], v[128:131]
    ds_read_b128 v[160:163], v16 offset:0
    s_add_u32 s71, s71, 1
    s_cmp_eq_u32 s71, 14
    s_cselect_b32 s71, 0, s71
    v_mfma_f32_16x16x32_bf16 v[144:147], v[208:211], v[204:207], v[144:147]
    ds_read_b128 v[164:167], v16 offset:2048
    v_mfma_f32_16x16x32_bf16 v[100:103], v[212:215], v[192:195], v[100:103]
    ds_read_b128 v[168:171], v16 offset:4096
    s_add_u32 m0, s77, s93
    s_nop 0
    buffer_load_dwordx4 v1, s[4:7], s73 offen sc1 lds
    v_mfma_f32_16x16x32_bf16 v[116:119], v[212:215], v[196:199], v[116:119]
    ds_read_b128 v[172:175], v16 offset:6144
    v_mfma_f32_16x16x32_bf16 v[132:135], v[212:215], v[200:203], v[132:135]
    ds_read_b64_tr_b16 v[180:181], v18 offset:0
    v_mfma_f32_16x16x32_bf16 v[148:151], v[212:215], v[204:207], v[148:151]
    ds_read_b64_tr_b16 v[182:183], v18 offset:4096
    v_mfma_f32_16x16x32_bf16 v[104:107], v[216:219], v[192:195], v[104:107]
    ds_read_b64_tr_b16 v[184:185], v19 offset:0
    v_mfma_f32_16x16x32_bf16 v[120:123], v[216:219], v[196:199], v[120:123]
    ds_read_b64_tr_b16 v[186:187], v19 offset:4096
    buffer_load_dwordx4 v1, s[4:7], s73 offen offset:1024 sc1 lds
    v_mfma_f32_16x16x32_bf16 v[136:139], v[216:219], v[200:203], v[136:139]
    ds_read_b64_tr_b16 v[188:189], v20 offset:0
    v_mfma_f32_16x16x32_bf16 v[152:155], v[216:219], v[204:207], v[152:155]
    ds_read_b64_tr_b16 v[190:191], v20 offset:4096
    v_mfma_f32_16x16x32_bf16 v[108:111], v[220:223], v[192:195], v[108:111]
    v_mfma_f32_16x16x32_bf16 v[124:127], v[220:223], v[196:199], v[124:127]
    v_mfma_f32_16x16x32_bf16 v[140:143], v[220:223], v[200:203], v[140:143]
    s_add_u32 m0, s77, s94
    s_nop 0
    buffer_load_dwordx4 v2, s[4:7], s73 offen sc1 lds
    v_mfma_f32_16x16x32_bf16 v[156:159], v[220:223], v[204:207], v[156:159]
    s_waitcnt lgkmcnt(0)
    v_mfma_f32_16x16x32_bf16 v[96:99], v[176:179], v[160:163], v[96:99]
    ds_read_b64_tr_b16 v[208:209], v17 offset:8192
    v_mfma_f32_16x16x32_bf16 v[112:115], v[176:179], v[164:167], v[112:115]
    ds_read_b64_tr_b16 v[210:211], v17 offset:12288
    buffer_load_dwordx4 v2, s[4:7], s73 offen offset:1024 sc1 lds
    v_mfma_f32_16x16x32_bf16 v[128:131], v[176:179], v[168:171], v[128:131]
    ds_read_b128 v[192:195], v16 offset:1024
    v_mfma_f32_16x16x32_bf16 v[144:147], v[176:179], v[172:175], v[144:147]
    ds_read_b128 v[196:199], v16 offset:3072
    v_mfma_f32_16x16x32_bf16 v[100:103], v[180:183], v[160:163], v[100:103]
    ds_read_b128 v[200:203], v16 offset:5120
    v_mfma_f32_16x16x32_bf16 v[116:119], v[180:183], v[164:167], v[116:119]
    ds_read_b128 v[204:207], v16 offset:7168
    v_mfma_f32_16x16x32_bf16 v[132:135], v[180:183], v[168:171], v[132:135]
    ds_read_b64_tr_b16 v[212:213], v18 offset:8192
    s_add_u32 m0, s77, s95
    s_nop 0
    buffer_load_dwordx4 v3, s[8:11], s74 offen lds
    v_mfma_f32_16x16x32_bf16 v[148:151], v[180:183], v[172:175], v[148:151]
    ds_read_b64_tr_b16 v[214:215], v18 offset:12288
    v_mfma_f32_16x16x32_bf16 v[104:107], v[184:187], v[160:163], v[104:107]
    ds_read_b64_tr_b16 v[216:217], v19 offset:8192
    v_mfma_f32_16x16x32_bf16 v[120:123], v[184:187], v[164:167], v[120:123]
    ds_read_b64_tr_b16 v[218:219], v19 offset:12288
    v_mfma_f32_16x16x32_bf16 v[136:139], v[184:187], v[168:171], v[136:139]
    ds_read_b64_tr_b16 v[220:221], v20 offset:8192
    v_mfma_f32_16x16x32_bf16 v[152:155], v[184:187], v[172:175], v[152:155]
    ds_read_b64_tr_b16 v[222:223], v20 offset:12288
    v_mfma_f32_16x16x32_bf16 v[108:111], v[188:191], v[160:163], v[108:111]
    s_add_u32 m0, s77, s96
    s_nop 0
    buffer_load_dwordx4 v4, s[8:11], s74 offen lds
    s_add_u32 s72, s72, 1
    s_add_u32 s73, s73, 32768
    v_mfma_f32_16x16x32_bf16 v[124:127], v[188:191], v[164:167], v[124:127]
    v_mfma_f32_16x16x32_bf16 v[140:143], v[188:191], v[168:171], v[140:143]
    v_mfma_f32_16x16x32_bf16 v[156:159], v[188:191], v[172:175], v[156:159]
    s_waitcnt vmcnt(14) lgkmcnt(0)
    s_barrier
    v_add_u32 v16, s76, v11
    v_add_u32 v17, s76, v12
    v_add_u32 v18, s76, v13
    v_add_u32 v19, s76, v14
    v_add_u32 v20, s76, v15
    v_mfma_f32_16x16x32_bf16 v[96:99], v[208:211], v[192:195], v[96:99]
    ds_read_b64_tr_b16 v[176:177], v17 offset:0
    s_mov_b32 s77, s75
    s_mov_b32 s75, s76
    s_add_u32 s76, s76, 49152
    s_cmp_lt_u32 s76, 147456
    s_cselect_b32 s76, s76, 0
    s_add_u32 s70, s70, 1
    v_mfma_f32_16x16x32_bf16 v[112:115], v[208:211], v[196:199], v[112:115]
    ds_read_b64_tr_b16 v[178:179], v17 offset:4096
    s_lshl_b32 s74, s71, 17
    s_add_u32 s74, s74, s79
    s_lshl_b32 s73, s71, 15
    s_add_u32 s73, s73, s90
    v_mfma_f32_16x16x32_bf16 v[128:131], v[208:211], v[200:203], v[128:131]
    ds_read_b128 v[160:163], v16 offset:0
    s_add_u32 s71, s71, 1
    s_cmp_eq_u32 s71, 14
    s_cselect_b32 s71, 0, s71
    v_mfma_f32_16x16x32_bf16 v[144:147], v[208:211], v[204:207], v[144:147]
    ds_read_b128 v[164:167], v16 offset:2048
    v_mfma_f32_16x16x32_bf16 v[100:103], v[212:215], v[192:195], v[100:103]
    ds_read_b128 v[168:171], v16 offset:4096
    s_add_u32 m0, s77, s93
    s_nop 0
    buffer_load_dwordx4 v1, s[4:7], s73 offen sc1 lds
    v_mfma_f32_16x16x32_bf16 v[116:119], v[212:215], v[196:199], v[116:119]
    ds_read_b128 v[172:175], v16 offset:6144
    v_mfma_f32_16x16x32_bf16 v[132:135], v[212:215], v[200:203], v[132:135]
    ds_read_b64_tr_b16 v[180:181], v18 offset:0
    v_mfma_f32_16x16x32_bf16 v[148:151], v[212:215], v[204:207], v[148:151]
    ds_read_b64_tr_b16 v[182:183], v18 offset:4096
    v_mfma_f32_16x16x32_bf16 v[104:107], v[216:219], v[192:195], v[104:107]
    ds_read_b64_tr_b16 v[184:185], v19 offset:0
    v_mfma_f32_16x16x32_bf16 v[120:123], v[216:219], v[196:199], v[120:123]
    ds_read_b64_tr_b16 v[186:187], v19 offset:4096
    buffer_load_dwordx4 v1, s[4:7], s73 offen offset:1024 sc1 lds
    v_mfma_f32_16x16x32_bf16 v[136:139], v[216:219], v[200:203], v[136:139]
    ds_read_b64_tr_b16 v[188:189], v20 offset:0
    v_mfma_f32_16x16x32_bf16 v[152:155], v[216:219], v[204:207], v[152:155]
    ds_read_b64_tr_b16 v[190:191], v20 offset:4096
    v_mfma_f32_16x16x32_bf16 v[108:111], v[220:223], v[192:195], v[108:111]
    v_mfma_f32_16x16x32_bf16 v[124:127], v[220:223], v[196:199], v[124:127]
    v_mfma_f32_16x16x32_bf16 v[140:143], v[220:223], v[200:203], v[140:143]
    s_add_u32 m0, s77, s94
    s_nop 0
    buffer_load_dwordx4 v2, s[4:7], s73 offen sc1 lds
    v_mfma_f32_16x16x32_bf16 v[156:159], v[220:223], v[204:207], v[156:159]
    s_waitcnt lgkmcnt(0)
    v_mfma_f32_16x16x32_bf16 v[96:99], v[176:179], v[160:163], v[96:99]
    ds_read_b64_tr_b16 v[208:209], v17 offset:8192
    v_mfma_f32_16x16x32_bf16 v[112:115], v[176:179], v[164:167], v[112:115]
    ds_read_b64_tr_b16 v[210:211], v17 offset:12288
    buffer_load_dwordx4 v2, s[4:7], s73 offen offset:1024 sc1 lds
    v_mfma_f32_16x16x32_bf16 v[128:131], v[176:179], v[168:171], v[128:131]
    ds_read_b128 v[192:195], v16 offset:1024
    v_mfma_f32_16x16x32_bf16 v[144:147], v[176:179], v[172:175], v[144:147]
    ds_read_b128 v[196:199], v16 offset:3072
    v_mfma_f32_16x16x32_bf16 v[100:103], v[180:183], v[160:163], v[100:103]
    ds_read_b128 v[200:203], v16 offset:5120
    v_mfma_f32_16x16x32_bf16 v[116:119], v[180:183], v[164:167], v[116:119]
    ds_read_b128 v[204:207], v16 offset:7168
    v_mfma_f32_16x16x32_bf16 v[132:135], v[180:183], v[168:171], v[132:135]
    ds_read_b64_tr_b16 v[212:213], v18 offset:8192
    s_add_u32 m0, s77, s95
    s_nop 0
    buffer_load_dwordx4 v3, s[8:11], s74 offen lds
    v_mfma_f32_16x16x32_bf16 v[148:151], v[180:183], v[172:175], v[148:151]
    ds_read_b64_tr_b16 v[214:215], v18 offset:12288
    v_mfma_f32_16x16x32_bf16 v[104:107], v[184:187], v[160:163], v[104:107]
    ds_read_b64_tr_b16 v[216:217], v19 offset:8192
    v_mfma_f32_16x16x32_bf16 v[120:123], v[184:187], v[164:167], v[120:123]
    ds_read_b64_tr_b16 v[218:219], v19 offset:12288
    v_mfma_f32_16x16x32_bf16 v[136:139], v[184:187], v[168:171], v[136:139]
    ds_read_b64_tr_b16 v[220:221], v20 offset:8192
    v_mfma_f32_16x16x32_bf16 v[152:155], v[184:187], v[172:175], v[152:155]
    ds_read_b64_tr_b16 v[222:223], v20 offset:12288
    v_mfma_f32_16x16x32_bf16 v[108:111], v[188:191], v[160:163], v[108:111]
    s_add_u32 m0, s77, s96
    s_nop 0
    buffer_load_dwordx4 v4, s[8:11], s74 offen lds
    s_add_u32 s72, s72, 1
    s_add_u32 s73, s73, 32768
    v_mfma_f32_16x16x32_bf16 v[124:127], v[188:191], v[164:167], v[124:127]
    v_mfma_f32_16x16x32_bf16 v[140:143], v[188:191], v[168:171], v[140:143]
    v_mfma_f32_16x16x32_bf16 v[156:159], v[188:191], v[172:175], v[156:159]
    s_waitcnt vmcnt(6) lgkmcnt(0)
    s_barrier
    v_add_u32 v16, s76, v11
    v_add_u32 v17, s76, v12
    v_add_u32 v18, s76, v13
    v_add_u32 v19, s76, v14
    v_add_u32 v20, s76, v15
    s_cmp_lg_u32 s64, 0
    s_cbranch_scc1 k2_nf
    s_add_u32 s80, s101, 23724032
    v_mov_b32 v21, 0
    v_mov_b32 v22, s100
    s_mov_b64 exec, 1
    buffer_store_dword v22, v21, s[16:19], s80 offen sc1
    s_mov_b64 exec, -1
k2_nf:
    v_mfma_f32_16x16x32_bf16 v[96:99], v[208:211], v[192:195], v[96:99]
    ds_read_b64_tr_b16 v[176:177], v17 offset:0
    s_mov_b32 s77, s75
    s_mov_b32 s75, s76
    s_add_u32 s76, s76, 49152
    s_cmp_lt_u32 s76, 147456
    s_cselect_b32 s76, s76, 0
    s_add_u32 s70, s70, 1
    v_mfma_f32_16x16x32_bf16 v[112:115], v[208:211], v[196:199], v[112:115]
    ds_read_b64_tr_b16 v[178:179], v17 offset:4096
    s_lshl_b32 s74, s71, 17
    s_add_u32 s74, s74, s79
    s_lshl_b32 s73, s71, 15
    s_add_u32 s73, s73, s90
    v_mfma_f32_16x16x32_bf16 v[128:131], v[208:211], v[200:203], v[128:131]
    ds_read_b128 v[160:163], v16 offset:0
    s_add_u32 s71, s71, 1
    s_cmp_eq_u32 s71, 14
    s_cselect_b32 s71, 0, s71
    v_mfma_f32_16x16x32_bf16 v[144:147], v[208:211], v[204:207], v[144:147]
    ds_read_b128 v[164:167], v16 offset:2048
    v_mfma_f32_16x16x32_bf16 v[100:103], v[212:215], v[192:195], v[100:103]
    ds_read_b128 v[168:171], v16 offset:4096
    s_add_u32 m0, s77, s93
    s_nop 0
    buffer_load_dwordx4 v1, s[4:7], s73 offen sc1 lds
    v_mfma_f32_16x16x32_bf16 v[116:119], v[212:215], v[196:199], v[116:119]
    ds_read_b128 v[172:175], v16 offset:6144
    v_mfma_f32_16x16x32_bf16 v[132:135], v[212:215], v[200:203], v[132:135]
    ds_read_b64_tr_b16 v[180:181], v18 offset:0
    v_mfma_f32_16x16x32_bf16 v[148:151], v[212:215], v[204:207], v[148:151]
    ds_read_b64_tr_b16 v[182:183], v18 offset:4096
    v_mfma_f32_16x16x32_bf16 v[104:107], v[216:219], v[192:195], v[104:107]
    ds_read_b64_tr_b16 v[184:185], v19 offset:0
    v_mfma_f32_16x16x32_bf16 v[120:123], v[216:219], v[196:199], v[120:123]
    ds_read_b64_tr_b16 v[186:187], v19 offset:4096
    buffer_load_dwordx4 v1, s[4:7], s73 offen offset:1024 sc1 lds
    v_mfma_f32_16x16x32_bf16 v[136:139], v[216:219], v[200:203], v[136:139]
    ds_read_b64_tr_b16 v[188:189], v20 offset:0
    v_mfma_f32_16x16x32_bf16 v[152:155], v[216:219], v[204:207], v[152:155]
    ds_read_b64_tr_b16 v[190:191], v20 offset:4096
    v_mfma_f32_16x16x32_bf16 v[108:111], v[220:223], v[192:195], v[108:111]
    v_mfma_f32_16x16x32_bf16 v[124:127], v[220:223], v[196:199], v[124:127]
    v_mfma_f32_16x16x32_bf16 v[140:143], v[220:223], v[200:203], v[140:143]
    s_add_u32 m0, s77, s94
    s_nop 0
    buffer_load_dwordx4 v2, s[4:7], s73 offen sc1 lds
    v_mfma_f32_16x16x32_bf16 v[156:159], v[220:223], v[204:207], v[156:159]
    s_waitcnt lgkmcnt(0)
    v_mfma_f32_16x16x32_bf16 v[96:99], v[176:179], v[160:163], v[96:99]
    ds_read_b64_tr_b16 v[208:209], v17 offset:8192
    v_mfma_f32_16x16x32_bf16 v[112:115], v[176:179], v[164:167], v[112:115]
    ds_read_b64_tr_b16 v[210:211], v17 offset:12288
    buffer_load_dwordx4 v2, s[4:7], s73 offen offset:1024 sc1 lds
    v_mfma_f32_16x16x32_bf16 v[128:131], v[176:179], v[168:171], v[128:131]
    ds_read_b128 v[192:195], v16 offset:1024
    v_mfma_f32_16x16x32_bf16 v[144:147], v[176:179], v[172:175], v[144:147]
    ds_read_b128 v[196:199], v16 offset:3072
    v_mfma_f32_16x16x32_bf16 v[100:103], v[180:183], v[160:163], v[100:103]
    ds_read_b128 v[200:203], v16 offset:5120
    v_mfma_f32_16x16x32_bf16 v[116:119], v[180:183], v[164:167], v[116:119]
    ds_read_b128 v[204:207], v16 offset:7168
    v_mfma_f32_16x16x32_bf16 v[132:135], v[180:183], v[168:171], v[132:135]
    ds_read_b64_tr_b16 v[212:213], v18 offset:8192
    s_add_u32 m0, s77, s95
    s_nop 0
    buffer_load_dwordx4 v3, s[8:11], s74 offen lds
    v_mfma_f32_16x16x32_bf16 v[148:151], v[180:183], v[172:175], v[148:151]
    ds_read_b64_tr_b16 v[214:215], v18 offset:12288
    v_mfma_f32_16x16x32_bf16 v[104:107], v[184:187], v[160:163], v[104:107]
    ds_read_b64_tr_b16 v[216:217], v19 offset:8192
    v_mfma_f32_16x16x32_bf16 v[120:123], v[184:187], v[164:167], v[120:123]
    ds_read_b64_tr_b16 v[218:219], v19 offset:12288
    v_mfma_f32_16x16x32_bf16 v[136:139], v[184:187], v[168:171], v[136:139]
    ds_read_b64_tr_b16 v[220:221], v20 offset:8192
    v_mfma_f32_16x16x32_bf16 v[152:155], v[184:187], v[172:175], v[152:155]
    ds_read_b64_tr_b16 v[222:223], v20 offset:12288
    v_mfma_f32_16x16x32_bf16 v[108:111], v[188:191], v[160:163], v[108:111]
    s_add_u32 m0, s77, s96
    s_nop 0
    buffer_load_dwordx4 v4, s[8:11], s74 offen lds
    s_add_u32 s72, s72, 1
    s_add_u32 s73, s73, 32768
    v_mfma_f32_16x16x32_bf16 v[124:127], v[188:191], v[164:167], v[124:127]
    v_mfma_f32_16x16x32_bf16 v[140:143], v[188:191], v[168:171], v[140:143]
    v_mfma_f32_16x16x32_bf16 v[156:159], v[188:191], v[172:175], v[156:159]
    s_cmp_eq_u32 s64, 0
    s_cbranch_scc1 k2_w7
    s_waitcnt vmcnt(6)
k2_w7:
    s_waitcnt vmcnt(7) lgkmcnt(0)
    s_barrier
    v_add_u32 v16, s76, v11
    v_add_u32 v17, s76, v12
    v_add_u32 v18, s76, v13
    v_add_u32 v19, s76, v14
    v_add_u32 v20, s76, v15
    v_mfma_f32_16x16x32_bf16 v[96:99], v[208:211], v[192:195], v[96:99]
    ds_read_b64_tr_b16 v[176:177], v17 offset:0
    s_mov_b32 s77, s75
    s_mov_b32 s75, s76
    s_add_u32 s76, s76, 49152
    s_cmp_lt_u32 s76, 147456
    s_cselect_b32 s76, s76, 0
    s_add_u32 s70, s70, 1
    v_mfma_f32_16x16x32_bf16 v[112:115], v[208:211], v[196:199], v[112:115]
    ds_read_b64_tr_b16 v[178:179], v17 offset:4096
    s_lshl_b32 s74, s71, 17
    s_add_u32 s74, s74, s79
    s_lshl_b32 s73, s71, 15
    s_add_u32 s73, s73, s90
    v_mfma_f32_16x16x32_bf16 v[128:131], v[208:211], v[200:203], v[128:131]
    ds_read_b128 v[160:163], v16 offset:0
    s_add_u32 s71, s71, 1
    s_cmp_eq_u32 s71, 14
    s_cselect_b32 s71, 0, s71
    v_mfma_f32_16x16x32_bf16 v[144:147], v[208:211], v[204:207], v[144:147]
    ds_read_b128 v[164:167], v16 offset:2048
    v_mfma_f32_16x16x32_bf16 v[100:103], v[212:215], v[192:195], v[100:103]
    ds_read_b128 v[168:171], v16 offset:4096
    s_add_u32 m0, s77, s93
    s_nop 0
    buffer_load_dwordx4 v1, s[4:7], s73 offen sc1 lds
    v_mfma_f32_16x16x32_bf16 v[116:119], v[212:215], v[196:199], v[116:119]
    ds_read_b128 v[172:175], v16 offset:6144
    v_mfma_f32_16x16x32_bf16 v[132:135], v[212:215], v[200:203], v[132:135]
    ds_read_b64_tr_b16 v[180:181], v18 offset:0
    v_mfma_f32_16x16x32_bf16 v[148:151], v[212:215], v[204:207], v[148:151]
    ds_read_b64_tr_b16 v[182:183], v18 offset:4096
    v_mfma_f32_16x16x32_bf16 v[104:107], v[216:219], v[192:195], v[104:107]
    ds_read_b64_tr_b16 v[184:185], v19 offset:0
    v_mfma_f32_16x16x32_bf16 v[120:123], v[216:219], v[196:199], v[120:123]
    ds_read_b64_tr_b16 v[186:187], v19 offset:4096
    buffer_load_dwordx4 v1, s[4:7], s73 offen offset:1024 sc1 lds
    v_mfma_f32_16x16x32_bf16 v[136:139], v[216:219], v[200:203], v[136:139]
    ds_read_b64_tr_b16 v[188:189], v20 offset:0
    v_mfma_f32_16x16x32_bf16 v[152:155], v[216:219], v[204:207], v[152:155]
    ds_read_b64_tr_b16 v[190:191], v20 offset:4096
    v_mfma_f32_16x16x32_bf16 v[108:111], v[220:223], v[192:195], v[108:111]
    v_mfma_f32_16x16x32_bf16 v[124:127], v[220:223], v[196:199], v[124:127]
    v_mfma_f32_16x16x32_bf16 v[140:143], v[220:223], v[200:203], v[140:143]
    s_add_u32 m0, s77, s94
    s_nop 0
    buffer_load_dwordx4 v2, s[4:7], s73 offen sc1 lds
    v_mfma_f32_16x16x32_bf16 v[156:159], v[220:223], v[204:207], v[156:159]
k2_lb:
    s_waitcnt lgkmcnt(0)
    v_mfma_f32_16x16x32_bf16 v[96:99], v[176:179], v[160:163], v[96:99]
    ds_read_b64_tr_b16 v[208:209], v17 offset:8192
    v_mfma_f32_16x16x32_bf16 v[112:115], v[176:179], v[164:167], v[112:115]
    ds_read_b64_tr_b16 v[210:211], v17 offset:12288
    buffer_load_dwordx4 v2, s[4:7], s73 offen offset:1024 sc1 lds
    v_mfma_f32_16x16x32_bf16 v[128:131], v[176:179], v[168:171], v[128:131]
    ds_read_b128 v[192:195], v16 offset:1024
    v_mfma_f32_16x16x32_bf16 v[144:147], v[176:179], v[172:175], v[144:147]
    ds_read_b128 v[196:199], v16 offset:3072
    v_mfma_f32_16x16x32_bf16 v[100:103], v[180:183], v[160:163], v[100:103]
    ds_read_b128 v[200:203], v16 offset:5120
    v_mfma_f32_16x16x32_bf16 v[116:119], v[180:183], v[164:167], v[116:119]
    ds_read_b128 v[204:207], v16 offset:7168
    v_mfma_f32_16x16x32_bf16 v[132:135], v[180:183], v[168:171], v[132:135]
    ds_read_b64_tr_b16 v[212:213], v18 offset:8192
    s_add_u32 m0, s77, s95
    s_nop 0
    buffer_load_dwordx4 v3, s[8:11], s74 offen lds
    v_mfma_f32_16x16x32_bf16 v[148:151], v[180:183], v[172:175], v[148:151]
    ds_read_b64_tr_b16 v[214:215], v18 offset:12288
    v_mfma_f32_16x16x32_bf16 v[104:107], v[184:187], v[160:163], v[104:107]
    ds_read_b64_tr_b16 v[216:217], v19 offset:8192
    v_mfma_f32_16x16x32_bf16 v[120:123], v[184:187], v[164:167], v[120:123]
    ds_read_b64_tr_b16 v[218:219], v19 offset:12288
    v_mfma_f32_16x16x32_bf16 v[136:139], v[184:187], v[168:171], v[136:139]
    ds_read_b64_tr_b16 v[220:221], v20 offset:8192
    v_mfma_f32_16x16x32_bf16 v[152:155], v[184:187], v[172:175], v[152:155]
    ds_read_b64_tr_b16 v[222:223], v20 offset:12288
    v_mfma_f32_16x16x32_bf16 v[108:111], v[188:191], v[160:163], v[108:111]
    s_add_u32 m0, s77, s96
    s_nop 0
    buffer_load_dwordx4 v4, s[8:11], s74 offen lds
    s_add_u32 s72, s72, 1
    s_add_u32 s73, s73, 32768
    v_mfma_f32_16x16x32_bf16 v[124:127], v[188:191], v[164:167], v[124:127]
    v_mfma_f32_16x16x32_bf16 v[140:143], v[188:191], v[168:171], v[140:143]
    v_mfma_f32_16x16x32_bf16 v[156:159], v[188:191], v[172:175], v[156:159]
    s_waitcnt vmcnt(6) lgkmcnt(0)
    s_barrier
    v_add_u32 v16, s76, v11
    v_add_u32 v17, s76, v12
    v_add_u32 v18, s76, v13
    v_add_u32 v19, s76, v14
    v_add_u32 v20, s76, v15
    v_mfma_f32_16x16x32_bf16 v[96:99], v[208:211], v[192:195], v[96:99]
    ds_read_b64_tr_b16 v[176:177], v17 offset:0
    s_mov_b32 s77, s75
    s_mov_b32 s75, s76
    s_add_u32 s76, s76, 49152
    s_cmp_lt_u32 s76, 147456
    s_cselect_b32 s76, s76, 0
    s_add_u32 s70, s70, 1
    v_mfma_f32_16x16x32_bf16 v[112:115], v[208:211], v[196:199], v[112:115]
    ds_read_b64_tr_b16 v[178:179], v17 offset:4096
    s_lshl_b32 s74, s71, 17
    s_add_u32 s74, s74, s79
    s_lshl_b32 s73, s71, 15
    s_add_u32 s73, s73, s90
    v_mfma_f32_16x16x32_bf16 v[128:131], v[208:211], v[200:203], v[128:131]
    ds_read_b128 v[160:163], v16 offset:0
    s_add_u32 s71, s71, 1
    s_cmp_eq_u32 s71, 14
    s_cselect_b32 s71, 0, s71
    v_mfma_f32_16x16x32_bf16 v[144:147], v[208:211], v[204:207], v[144:147]
    ds_read_b128 v[164:167], v16 offset:2048
    v_mfma_f32_16x16x32_bf16 v[100:103], v[212:215], v[192:195], v[100:103]
    ds_read_b128 v[168:171], v16 offset:4096
    s_add_u32 m0, s77, s93
    s_nop 0
    buffer_load_dwordx4 v1, s[4:7], s73 offen sc1 lds
    v_mfma_f32_16x16x32_bf16 v[116:119], v[212:215], v[196:199], v[116:119]
    ds_read_b128 v[172:175], v16 offset:6144
    v_mfma_f32_16x16x32_bf16 v[132:135], v[212:215], v[200:203], v[132:135]
    ds_read_b64_tr_b16 v[180:181], v18 offset:0
    v_mfma_f32_16x16x32_bf16 v[148:151], v[212:215], v[204:207], v[148:151]
    ds_read_b64_tr_b16 v[182:183], v18 offset:4096
    v_mfma_f32_16x16x32_bf16 v[104:107], v[216:219], v[192:195], v[104:107]
    ds_read_b64_tr_b16 v[184:185], v19 offset:0
    v_mfma_f32_16x16x32_bf16 v[120:123], v[216:219], v[196:199], v[120:123]
    ds_read_b64_tr_b16 v[186:187], v19 offset:4096
    buffer_load_dwordx4 v1, s[4:7], s73 offen offset:1024 sc1 lds
    v_mfma_f32_16x16x32_bf16 v[136:139], v[216:219], v[200:203], v[136:139]
    ds_read_b64_tr_b16 v[188:189], v20 offset:0
    v_mfma_f32_16x16x32_bf16 v[152:155], v[216:219], v[204:207], v[152:155]
    ds_read_b64_tr_b16 v[190:191], v20 offset:4096
    v_mfma_f32_16x16x32_bf16 v[108:111], v[220:223], v[192:195], v[108:111]
    v_mfma_f32_16x16x32_bf16 v[124:127], v[220:223], v[196:199], v[124:127]
    v_mfma_f32_16x16x32_bf16 v[140:143], v[220:223], v[200:203], v[140:143]
    s_add_u32 m0, s77, s94
    s_nop 0
    buffer_load_dwordx4 v2, s[4:7], s73 offen sc1 lds
    v_mfma_f32_16x16x32_bf16 v[156:159], v[220:223], v[204:207], v[156:159]
    s_cmp_lt_u32 s70, 10
    s_cbranch_scc1 k2_lb
    s_waitcnt lgkmcnt(0)
    v_mfma_f32_16x16x32_bf16 v[96:99], v[176:179], v[160:163], v[96:99]
    ds_read_b64_tr_b16 v[208:209], v17 offset:8192
    v_mfma_f32_16x16x32_bf16 v[112:115], v[176:179], v[164:167], v[112:115]
    ds_read_b64_tr_b16 v[210:211], v17 offset:12288
    buffer_load_dwordx4 v2, s[4:7], s73 offen offset:1024 sc1 lds
    v_mfma_f32_16x16x32_bf16 v[128:131], v[176:179], v[168:171], v[128:131]
    ds_read_b128 v[192:195], v16 offset:1024
    v_mfma_f32_16x16x32_bf16 v[144:147], v[176:179], v[172:175], v[144:147]
    ds_read_b128 v[196:199], v16 offset:3072
    v_mfma_f32_16x16x32_bf16 v[100:103], v[180:183], v[160:163], v[100:103]
    ds_read_b128 v[200:203], v16 offset:5120
    v_mfma_f32_16x16x32_bf16 v[116:119], v[180:183], v[164:167], v[116:119]
    ds_read_b128 v[204:207], v16 offset:7168
    v_mfma_f32_16x16x32_bf16 v[132:135], v[180:183], v[168:171], v[132:135]
    ds_read_b64_tr_b16 v[212:213], v18 offset:8192
    s_add_u32 m0, s77, s95
    s_nop 0
    buffer_load_dwordx4 v3, s[8:11], s74 offen lds
    v_mfma_f32_16x16x32_bf16 v[148:151], v[180:183], v[172:175], v[148:151]
    ds_read_b64_tr_b16 v[214:215], v18 offset:12288
    v_mfma_f32_16x16x32_bf16 v[104:107], v[184:187], v[160:163], v[104:107]
    ds_read_b64_tr_b16 v[216:217], v19 offset:8192
    v_mfma_f32_16x16x32_bf16 v[120:123], v[184:187], v[164:167], v[120:123]
    ds_read_b64_tr_b16 v[218:219], v19 offset:12288
    v_mfma_f32_16x16x32_bf16 v[136:139], v[184:187], v[168:171], v[136:139]
    ds_read_b64_tr_b16 v[220:221], v20 offset:8192
    v_mfma_f32_16x16x32_bf16 v[152:155], v[184:187], v[172:175], v[152:155]
    ds_read_b64_tr_b16 v[222:223], v20 offset:12288
    v_mfma_f32_16x16x32_bf16 v[108:111], v[188:191], v[160:163], v[108:111]
    s_add_u32 m0, s77, s96
    s_nop 0
    buffer_load_dwordx4 v4, s[8:11], s74 offen lds
    s_add_u32 s72, s72, 1
    s_add_u32 s73, s73, 32768
    v_mfma_f32_16x16x32_bf16 v[124:127], v[188:191], v[164:167], v[124:127]
    v_mfma_f32_16x16x32_bf16 v[140:143], v[188:191], v[168:171], v[140:143]
    v_mfma_f32_16x16x32_bf16 v[156:159], v[188:191], v[172:175], v[156:159]
    s_waitcnt vmcnt(6) lgkmcnt(0)
    s_barrier
    v_add_u32 v16, s76, v11
    v_add_u32 v17, s76, v12
    v_add_u32 v18, s76, v13
    v_add_u32 v19, s76, v14
    v_add_u32 v20, s76, v15
    v_and_b32 v21, 31, v0
    v_lshlrev_b32 v21, 7, v21
    s_lshl_b32 s91, s67, 12
    s_add_u32 s91, s91, 23724032
    buffer_load_dword v22, v21, s[16:19], s91 offen sc1
    v_mfma_f32_16x16x32_bf16 v[96:99], v[208:211], v[192:195], v[96:99]
    ds_read_b64_tr_b16 v[176:177], v17 offset:0
    s_mov_b32 s77, s75
    s_mov_b32 s75, s76
    s_add_u32 s76, s76, 49152
    s_cmp_lt_u32 s76, 147456
    s_cselect_b32 s76, s76, 0
    s_add_u32 s70, s70, 1
    v_mfma_f32_16x16x32_bf16 v[112:115], v[208:211], v[196:199], v[112:115]
    ds_read_b64_tr_b16 v[178:179], v17 offset:4096
    s_lshl_b32 s74, s71, 17
    s_add_u32 s74, s74, s79
    s_lshl_b32 s73, s71, 15
    s_add_u32 s73, s73, s90
    v_mfma_f32_16x16x32_bf16 v[128:131], v[208:211], v[200:203], v[128:131]
    ds_read_b128 v[160:163], v16 offset:0
    s_add_u32 s71, s71, 1
    s_cmp_eq_u32 s71, 14
    s_cselect_b32 s71, 0, s71
    v_mfma_f32_16x16x32_bf16 v[144:147], v[208:211], v[204:207], v[144:147]
    ds_read_b128 v[164:167], v16 offset:2048
    v_mfma_f32_16x16x32_bf16 v[100:103], v[212:215], v[192:195], v[100:103]
    ds_read_b128 v[168:171], v16 offset:4096
    s_add_u32 m0, s77, s93
    s_nop 0
    buffer_load_dwordx4 v1, s[4:7], s73 offen sc1 lds
    v_mfma_f32_16x16x32_bf16 v[116:119], v[212:215], v[196:199], v[116:119]
    ds_read_b128 v[172:175], v16 offset:6144
    v_mfma_f32_16x16x32_bf16 v[132:135], v[212:215], v[200:203], v[132:135]
    ds_read_b64_tr_b16 v[180:181], v18 offset:0
    v_mfma_f32_16x16x32_bf16 v[148:151], v[212:215], v[204:207], v[148:151]
    ds_read_b64_tr_b16 v[182:183], v18 offset:4096
    v_mfma_f32_16x16x32_bf16 v[104:107], v[216:219], v[192:195], v[104:107]
    ds_read_b64_tr_b16 v[184:185], v19 offset:0
    v_mfma_f32_16x16x32_bf16 v[120:123], v[216:219], v[196:199], v[120:123]
    ds_read_b64_tr_b16 v[186:187], v19 offset:4096
    buffer_load_dwordx4 v1, s[4:7], s73 offen offset:1024 sc1 lds
    v_mfma_f32_16x16x32_bf16 v[136:139], v[216:219], v[200:203], v[136:139]
    ds_read_b64_tr_b16 v[188:189], v20 offset:0
    v_mfma_f32_16x16x32_bf16 v[152:155], v[216:219], v[204:207], v[152:155]
    ds_read_b64_tr_b16 v[190:191], v20 offset:4096
    v_mfma_f32_16x16x32_bf16 v[108:111], v[220:223], v[192:195], v[108:111]
    v_mfma_f32_16x16x32_bf16 v[124:127], v[220:223], v[196:199], v[124:127]
    v_mfma_f32_16x16x32_bf16 v[140:143], v[220:223], v[200:203], v[140:143]
    s_add_u32 m0, s77, s94
    s_nop 0
    buffer_load_dwordx4 v2, s[4:7], s73 offen sc1 lds
    v_mfma_f32_16x16x32_bf16 v[156:159], v[220:223], v[204:207], v[156:159]
    s_waitcnt lgkmcnt(0)
    v_mfma_f32_16x16x32_bf16 v[96:99], v[176:179], v[160:163], v[96:99]
    ds_read_b64_tr_b16 v[208:209], v17 offset:8192
    v_mfma_f32_16x16x32_bf16 v[112:115], v[176:179], v[164:167], v[112:115]
    ds_read_b64_tr_b16 v[210:211], v17 offset:12288
    buffer_load_dwordx4 v2, s[4:7], s73 offen offset:1024 sc1 lds
    v_mfma_f32_16x16x32_bf16 v[128:131], v[176:179], v[168:171], v[128:131]
    ds_read_b128 v[192:195], v16 offset:1024
    v_mfma_f32_16x16x32_bf16 v[144:147], v[176:179], v[172:175], v[144:147]
    ds_read_b128 v[196:199], v16 offset:3072
    v_mfma_f32_16x16x32_bf16 v[100:103], v[180:183], v[160:163], v[100:103]
    ds_read_b128 v[200:203], v16 offset:5120
    v_mfma_f32_16x16x32_bf16 v[116:119], v[180:183], v[164:167], v[116:119]
    ds_read_b128 v[204:207], v16 offset:7168
    v_mfma_f32_16x16x32_bf16 v[132:135], v[180:183], v[168:171], v[132:135]
    ds_read_b64_tr_b16 v[212:213], v18 offset:8192
    s_add_u32 m0, s77, s95
    s_nop 0
    buffer_load_dwordx4 v3, s[8:11], s74 offen lds
    v_mfma_f32_16x16x32_bf16 v[148:151], v[180:183], v[172:175], v[148:151]
    ds_read_b64_tr_b16 v[214:215], v18 offset:12288
    v_mfma_f32_16x16x32_bf16 v[104:107], v[184:187], v[160:163], v[104:107]
    ds_read_b64_tr_b16 v[216:217], v19 offset:8192
    v_mfma_f32_16x16x32_bf16 v[120:123], v[184:187], v[164:167], v[120:123]
    ds_read_b64_tr_b16 v[218:219], v19 offset:12288
    v_mfma_f32_16x16x32_bf16 v[136:139], v[184:187], v[168:171], v[136:139]
    ds_read_b64_tr_b16 v[220:221], v20 offset:8192
    v_mfma_f32_16x16x32_bf16 v[152:155], v[184:187], v[172:175], v[152:155]
    ds_read_b64_tr_b16 v[222:223], v20 offset:12288
    v_mfma_f32_16x16x32_bf16 v[108:111], v[188:191], v[160:163], v[108:111]
    s_add_u32 m0, s77, s96
    s_nop 0
    buffer_load_dwordx4 v4, s[8:11], s74 offen lds
    s_add_u32 s72, s72, 1
    s_add_u32 s73, s73, 32768
    v_mfma_f32_16x16x32_bf16 v[124:127], v[188:191], v[164:167], v[124:127]
    v_mfma_f32_16x16x32_bf16 v[140:143], v[188:191], v[168:171], v[140:143]
    v_mfma_f32_16x16x32_bf16 v[156:159], v[188:191], v[172:175], v[156:159]
    s_waitcnt vmcnt(6) lgkmcnt(0)
    s_barrier
    v_add_u32 v16, s76, v11
    v_add_u32 v17, s76, v12
    v_add_u32 v18, s76, v13
    v_add_u32 v19, s76, v14
    v_add_u32 v20, s76, v15
k2_hp:
    v_cmp_ne_u32 vcc, s100, v22
    s_nop 3
    s_cbranch_vccz k2_hq
    s_sleep 2
    buffer_load_dword v22, v21, s[16:19], s91 offen sc1
    s_waitcnt vmcnt(0)
    s_branch k2_hp
k2_hq:
    v_mfma_f32_16x16x32_bf16 v[96:99], v[208:211], v[192:195], v[96:99]
    ds_read_b64_tr_b16 v[176:177], v17 offset:0
    s_mov_b32 s77, s75
    s_mov_b32 s75, s76
    s_add_u32 s76, s76, 49152
    s_cmp_lt_u32 s76, 147456
    s_cselect_b32 s76, s76, 0
    s_add_u32 s70, s70, 1
    v_mfma_f32_16x16x32_bf16 v[112:115], v[208:211], v[196:199], v[112:115]
    ds_read_b64_tr_b16 v[178:179], v17 offset:4096
    s_mul_i32 s73, s67, 88
    s_lshl_b32 s80, s69, 3
    s_add_u32 s73, s73, s80
    s_lshl_b32 s73, s73, 15
    s_mov_b32 s10, 2097152
    v_mov_b32 v3, v5
    v_mov_b32 v4, v6
    v_mfma_f32_16x16x32_bf16 v[128:131], v[208:211], v[200:203], v[128:131]
    ds_read_b128 v[160:163], v16 offset:0
    s_bitcmp1_b32 s72, 0
    s_cselect_b64 s[8:9], s[44:45], s[42:43]
    s_lshr_b32 s80, s72, 1
    s_lshl_b32 s80, s80, 7
    s_add_u32 s74, s80, s97
    v_mfma_f32_16x16x32_bf16 v[144:147], v[208:211], v[204:207], v[144:147]
    ds_read_b128 v[164:167], v16 offset:2048
    v_mfma_f32_16x16x32_bf16 v[100:103], v[212:215], v[192:195], v[100:103]
    ds_read_b128 v[168:171], v16 offset:4096
    s_add_u32 m0, s77, s93
    s_nop 0
    buffer_load_dwordx4 v1, s[4:7], s73 offen sc1 lds
    v_mfma_f32_16x16x32_bf16 v[116:119], v[212:215], v[196:199], v[116:119]
    ds_read_b128 v[172:175], v16 offset:6144
    v_mfma_f32_16x16x32_bf16 v[132:135], v[212:215], v[200:203], v[132:135]
    ds_read_b64_tr_b16 v[180:181], v18 offset:0
    v_mfma_f32_16x16x32_bf16 v[148:151], v[212:215], v[204:207], v[148:151]
    ds_read_b64_tr_b16 v[182:183], v18 offset:4096
    v_mfma_f32_16x16x32_bf16 v[104:107], v[216:219], v[192:195], v[104:107]
    ds_read_b64_tr_b16 v[184:185], v19 offset:0
    v_mfma_f32_16x16x32_bf16 v[120:123], v[216:219], v[196:199], v[120:123]
    ds_read_b64_tr_b16 v[186:187], v19 offset:4096
    buffer_load_dwordx4 v1, s[4:7], s73 offen offset:1024 sc1 lds
    v_mfma_f32_16x16x32_bf16 v[136:139], v[216:219], v[200:203], v[136:139]
    ds_read_b64_tr_b16 v[188:189], v20 offset:0
    v_mfma_f32_16x16x32_bf16 v[152:155], v[216:219], v[204:207], v[152:155]
    ds_read_b64_tr_b16 v[190:191], v20 offset:4096
    v_mfma_f32_16x16x32_bf16 v[108:111], v[220:223], v[192:195], v[108:111]
    v_mfma_f32_16x16x32_bf16 v[124:127], v[220:223], v[196:199], v[124:127]
    v_mfma_f32_16x16x32_bf16 v[140:143], v[220:223], v[200:203], v[140:143]
    s_add_u32 m0, s77, s94
    s_nop 0
    buffer_load_dwordx4 v2, s[4:7], s73 offen sc1 lds
    v_mfma_f32_16x16x32_bf16 v[156:159], v[220:223], v[204:207], v[156:159]
    s_waitcnt lgkmcnt(0)
    v_mfma_f32_16x16x32_bf16 v[96:99], v[176:179], v[160:163], v[96:99]
    ds_read_b64_tr_b16 v[208:209], v17 offset:8192
    v_mfma_f32_16x16x32_bf16 v[112:115], v[176:179], v[164:167], v[112:115]
    ds_read_b64_tr_b16 v[210:211], v17 offset:12288
    buffer_load_dwordx4 v2, s[4:7], s73 offen offset:1024 sc1 lds
    v_mfma_f32_16x16x32_bf16 v[128:131], v[176:179], v[168:171], v[128:131]
    ds_read_b128 v[192:195], v16 offset:1024
    v_mfma_f32_16x16x32_bf16 v[144:147], v[176:179], v[172:175], v[144:147]
    ds_read_b128 v[196:199], v16 offset:3072
    v_mfma_f32_16x16x32_bf16 v[100:103], v[180:183], v[160:163], v[100:103]
    ds_read_b128 v[200:203], v16 offset:5120
    v_mfma_f32_16x16x32_bf16 v[116:119], v[180:183], v[164:167], v[116:119]
    ds_read_b128 v[204:207], v16 offset:7168
    v_mfma_f32_16x16x32_bf16 v[132:135], v[180:183], v[168:171], v[132:135]
    ds_read_b64_tr_b16 v[212:213], v18 offset:8192
    s_add_u32 m0, s77, s95
    s_nop 0
    buffer_load_dwordx4 v3, s[8:11], s74 offen lds
    v_mfma_f32_16x16x32_bf16 v[148:151], v[180:183], v[172:175], v[148:151]
    ds_read_b64_tr_b16 v[214:215], v18 offset:12288
    v_mfma_f32_16x16x32_bf16 v[104:107], v[184:187], v[160:163], v[104:107]
    ds_read_b64_tr_b16 v[216:217], v19 offset:8192
    v_mfma_f32_16x16x32_bf16 v[120:123], v[184:187], v[164:167], v[120:123]
    ds_read_b64_tr_b16 v[218:219], v19 offset:12288
    v_mfma_f32_16x16x32_bf16 v[136:139], v[184:187], v[168:171], v[136:139]
    ds_read_b64_tr_b16 v[220:221], v20 offset:8192
    v_mfma_f32_16x16x32_bf16 v[152:155], v[184:187], v[172:175], v[152:155]
    ds_read_b64_tr_b16 v[222:223], v20 offset:12288
    v_mfma_f32_16x16x32_bf16 v[108:111], v[188:191], v[160:163], v[108:111]
    s_add_u32 m0, s77, s96
    s_nop 0
    buffer_load_dwordx4 v4, s[8:11], s74 offen lds
    s_add_u32 s72, s72, 1
    s_add_u32 s73, s73, 32768
    v_mfma_f32_16x16x32_bf16 v[124:127], v[188:191], v[164:167], v[124:127]
    v_mfma_f32_16x16x32_bf16 v[140:143], v[188:191], v[168:171], v[140:143]
    v_mfma_f32_16x16x32_bf16 v[156:159], v[188:191], v[172:175], v[156:159]
    s_waitcnt vmcnt(6) lgkmcnt(0)
    s_barrier
    v_add_u32 v16, s76, v11
    v_add_u32 v17, s76, v12
    v_add_u32 v18, s76, v13
    v_add_u32 v19, s76, v14
    v_add_u32 v20, s76, v15
    s_mov_b32 s12, s62
    s_mov_b32 s13, s63
    s_mov_b32 s14, 268435456
    s_mov_b32 s15, 0x00020000
    s_mov_b32 s16, s32
    s_mov_b32 s17, s33
    s_mov_b32 s18, 4194304
    s_mov_b32 s19, 0x00020000
    s_mov_b32 s20, s48
    s_mov_b32 s21, s49
    s_mov_b32 s22, 2048
    s_mov_b32 s23, 0x00020000
    v_lshrrev_b32 v26, 2, v23
    v_lshlrev_b32 v26, 4, v26
    v_and_b32 v27, 3, v23
    s_lshl_b32 s80, s67, 8
    s_lshl_b32 s81, s65, 6
    s_add_u32 s80, s80, s81
    v_add3_u32 v26, v26, v27, s80
    v_lshlrev_b32 v27, 2, v26
    s_add_u32 s81, s69, 0
    s_and_b32 s81, s81, 3
    s_lshl_b32 s81, s81, 4
    s_add_u32 s81, s81, 23068672
    buffer_load_dword v224, v27, s[12:15], s81 offen sc1
    s_add_u32 s81, s69, 1
    s_and_b32 s81, s81, 3
    s_lshl_b32 s81, s81, 4
    s_add_u32 s81, s81, 23068672
    buffer_load_dword v225, v27, s[12:15], s81 offen sc1
    s_add_u32 s81, s69, 2
    s_and_b32 s81, s81, 3
    s_lshl_b32 s81, s81, 4
    s_add_u32 s81, s81, 23068672
    buffer_load_dword v226, v27, s[12:15], s81 offen sc1
    s_add_u32 s81, s69, 3
    s_and_b32 s81, s81, 3
    s_lshl_b32 s81, s81, 4
    s_add_u32 s81, s81, 23068672
    buffer_load_dword v227, v27, s[12:15], s81 offen sc1
    s_lshl_b32 s81, s69, 2
    v_add_u32 v26, s81, v26
    s_lshl_b32 s80, s78, 7
    s_lshl_b32 s81, s66, 6
    s_add_u32 s80, s80, s81
    v_lshl_add_u32 v27, v24, 2, s80
    v_lshlrev_b32 v28, 1, v27
    v_lshl_add_u32 v29, v26, 11, v28
    v_lshlrev_b32 v31, 2, v27
    v_lshl_add_u32 v31, v26, 12, v31
    buffer_load_dwordx2 v[228:229], v29, s[16:19], 0 offen offset:0
    buffer_load_dwordx2 v[236:237], v28, s[20:23], 0 offen offset:0
    buffer_load_dwordx2 v[230:231], v29, s[16:19], 0 offen offset:32
    buffer_load_dwordx2 v[238:239], v28, s[20:23], 0 offen offset:32
    buffer_load_dwordx2 v[232:233], v29, s[16:19], 0 offen offset:64
    buffer_load_dwordx2 v[240:241], v28, s[20:23], 0 offen offset:64
    buffer_load_dwordx2 v[234:235], v29, s[16:19], 0 offen offset:96
    buffer_load_dwordx2 v[242:243], v28, s[20:23], 0 offen offset:96
    v_mfma_f32_16x16x32_bf16 v[96:99], v[208:211], v[192:195], v[96:99]
    ds_read_b64_tr_b16 v[176:177], v17 offset:0
    s_mov_b32 s77, s75
    s_mov_b32 s75, s76
    s_add_u32 s76, s76, 49152
    s_cmp_lt_u32 s76, 147456
    s_cselect_b32 s76, s76, 0
    s_add_u32 s70, s70, 1
    v_mfma_f32_16x16x32_bf16 v[112:115], v[208:211], v[196:199], v[112:115]
    ds_read_b64_tr_b16 v[178:179], v17 offset:4096
    s_bitcmp1_b32 s72, 0
    s_cselect_b64 s[8:9], s[44:45], s[42:43]
    s_lshr_b32 s80, s72, 1
    s_lshl_b32 s80, s80, 7
    s_add_u32 s74, s80, s97
    v_mfma_f32_16x16x32_bf16 v[128:131], v[208:211], v[200:203], v[128:131]
    ds_read_b128 v[160:163], v16 offset:0
    v_mfma_f32_16x16x32_bf16 v[144:147], v[208:211], v[204:207], v[144:147]
    ds_read_b128 v[164:167], v16 offset:2048
    v_mfma_f32_16x16x32_bf16 v[100:103], v[212:215], v[192:195], v[100:103]
    ds_read_b128 v[168:171], v16 offset:4096
    s_add_u32 m0, s77, s93
    s_nop 0
    buffer_load_dwordx4 v1, s[4:7], s73 offen sc1 lds
    v_mfma_f32_16x16x32_bf16 v[116:119], v[212:215], v[196:199], v[116:119]
    ds_read_b128 v[172:175], v16 offset:6144
    v_mfma_f32_16x16x32_bf16 v[132:135], v[212:215], v[200:203], v[132:135]
    ds_read_b64_tr_b16 v[180:181], v18 offset:0
    v_mfma_f32_16x16x32_bf16 v[148:151], v[212:215], v[204:207], v[148:151]
    ds_read_b64_tr_b16 v[182:183], v18 offset:4096
    v_mfma_f32_16x16x32_bf16 v[104:107], v[216:219], v[192:195], v[104:107]
    ds_read_b64_tr_b16 v[184:185], v19 offset:0
    v_mfma_f32_16x16x32_bf16 v[120:123], v[216:219], v[196:199], v[120:123]
    ds_read_b64_tr_b16 v[186:187], v19 offset:4096
    buffer_load_dwordx4 v1, s[4:7], s73 offen offset:1024 sc1 lds
    v_mfma_f32_16x16x32_bf16 v[136:139], v[216:219], v[200:203], v[136:139]
    ds_read_b64_tr_b16 v[188:189], v20 offset:0
    v_mfma_f32_16x16x32_bf16 v[152:155], v[216:219], v[204:207], v[152:155]
    ds_read_b64_tr_b16 v[190:191], v20 offset:4096
    v_mfma_f32_16x16x32_bf16 v[108:111], v[220:223], v[192:195], v[108:111]
    v_mfma_f32_16x16x32_bf16 v[124:127], v[220:223], v[196:199], v[124:127]
    v_mfma_f32_16x16x32_bf16 v[140:143], v[220:223], v[200:203], v[140:143]
    s_add_u32 m0, s77, s94
    s_nop 0
    buffer_load_dwordx4 v2, s[4:7], s73 offen sc1 lds
    v_mfma_f32_16x16x32_bf16 v[156:159], v[220:223], v[204:207], v[156:159]
    s_waitcnt lgkmcnt(0)
    v_mfma_f32_16x16x32_bf16 v[96:99], v[176:179], v[160:163], v[96:99]
    ds_read_b64_tr_b16 v[208:209], v17 offset:8192
    v_mfma_f32_16x16x32_bf16 v[112:115], v[176:179], v[164:167], v[112:115]
    ds_read_b64_tr_b16 v[210:211], v17 offset:12288
    buffer_load_dwordx4 v2, s[4:7], s73 offen offset:1024 sc1 lds
    v_mfma_f32_16x16x32_bf16 v[128:131], v[176:179], v[168:171], v[128:131]
    ds_read_b128 v[192:195], v16 offset:1024
    v_mfma_f32_16x16x32_bf16 v[144:147], v[176:179], v[172:175], v[144:147]
    ds_read_b128 v[196:199], v16 offset:3072
    v_mfma_f32_16x16x32_bf16 v[100:103], v[180:183], v[160:163], v[100:103]
    ds_read_b128 v[200:203], v16 offset:5120
    v_mfma_f32_16x16x32_bf16 v[116:119], v[180:183], v[164:167], v[116:119]
    ds_read_b128 v[204:207], v16 offset:7168
    v_mfma_f32_16x16x32_bf16 v[132:135], v[180:183], v[168:171], v[132:135]
    ds_read_b64_tr_b16 v[212:213], v18 offset:8192
    s_add_u32 m0, s77, s95
    s_nop 0
    buffer_load_dwordx4 v3, s[8:11], s74 offen lds
    v_mfma_f32_16x16x32_bf16 v[148:151], v[180:183], v[172:175], v[148:151]
    ds_read_b64_tr_b16 v[214:215], v18 offset:12288
    v_mfma_f32_16x16x32_bf16 v[104:107], v[184:187], v[160:163], v[104:107]
    ds_read_b64_tr_b16 v[216:217], v19 offset:8192
    v_mfma_f32_16x16x32_bf16 v[120:123], v[184:187], v[164:167], v[120:123]
    ds_read_b64_tr_b16 v[218:219], v19 offset:12288
    v_mfma_f32_16x16x32_bf16 v[136:139], v[184:187], v[168:171], v[136:139]
    ds_read_b64_tr_b16 v[220:221], v20 offset:8192
    v_mfma_f32_16x16x32_bf16 v[152:155], v[184:187], v[172:175], v[152:155]
    ds_read_b64_tr_b16 v[222:223], v20 offset:12288
    v_mfma_f32_16x16x32_bf16 v[108:111], v[188:191], v[160:163], v[108:111]
    s_add_u32 m0, s77, s96
    s_nop 0
    buffer_load_dwordx4 v4, s[8:11], s74 offen lds
    s_add_u32 s72, s72, 1
    s_add_u32 s73, s73, 32768
    v_mfma_f32_16x16x32_bf16 v[124:127], v[188:191], v[164:167], v[124:127]
    v_mfma_f32_16x16x32_bf16 v[140:143], v[188:191], v[168:171], v[140:143]
    v_mfma_f32_16x16x32_bf16 v[156:159], v[188:191], v[172:175], v[156:159]
    s_waitcnt vmcnt(18) lgkmcnt(0)
    s_barrier
    v_add_u32 v16, s76, v7
    v_add_u32 v17, s76, v8
    v_add_u32 v18, s76, v9
    v_add_u32 v19, s76, v10
    v_mfma_f32_16x16x32_bf16 v[96:99], v[208:211], v[192:195], v[96:99]
    ds_read_b128 v[176:179], v18 offset:0
    s_mov_b32 s77, s75
    s_mov_b32 s75, s76
    s_add_u32 s76, s76, 49152
    s_cmp_lt_u32 s76, 147456
    s_cselect_b32 s76, s76, 0
    s_add_u32 s70, s70, 1
    v_mfma_f32_16x16x32_bf16 v[112:115], v[208:211], v[196:199], v[112:115]
    ds_read_b64_tr_b16 v[160:161], v16 offset:0
    s_bitcmp1_b32 s72, 0
    s_cselect_b64 s[8:9], s[44:45], s[42:43]
    s_lshr_b32 s80, s72, 1
    s_lshl_b32 s80, s80, 7
    s_add_u32 s74, s80, s97
    v_mfma_f32_16x16x32_bf16 v[128:131], v[208:211], v[200:203], v[128:131]
    ds_read_b64_tr_b16 v[162:163], v17 offset:0
    v_mfma_f32_16x16x32_bf16 v[144:147], v[208:211], v[204:207], v[144:147]
    ds_read_b64_tr_b16 v[164:165], v16 offset:2048
    v_mfma_f32_16x16x32_bf16 v[100:103], v[212:215], v[192:195], v[100:103]
    ds_read_b64_tr_b16 v[166:167], v17 offset:2048
    s_add_u32 m0, s77, s93
    s_nop 0
    buffer_load_dwordx4 v1, s[4:7], s73 offen sc1 lds
    v_mfma_f32_16x16x32_bf16 v[116:119], v[212:215], v[196:199], v[116:119]
    ds_read_b64_tr_b16 v[168:169], v16 offset:4096
    v_mfma_f32_16x16x32_bf16 v[132:135], v[212:215], v[200:203], v[132:135]
    ds_read_b64_tr_b16 v[170:171], v17 offset:4096
    v_mfma_f32_16x16x32_bf16 v[148:151], v[212:215], v[204:207], v[148:151]
    ds_read_b64_tr_b16 v[172:173], v16 offset:6144
    v_mfma_f32_16x16x32_bf16 v[104:107], v[216:219], v[192:195], v[104:107]
    ds_read_b64_tr_b16 v[174:175], v17 offset:6144
    v_mfma_f32_16x16x32_bf16 v[120:123], v[216:219], v[196:199], v[120:123]
    ds_read_b128 v[180:183], v18 offset:2048
    buffer_load_dwordx4 v1, s[4:7], s73 offen offset:1024 sc1 lds
    v_mfma_f32_16x16x32_bf16 v[136:139], v[216:219], v[200:203], v[136:139]
    ds_read_b128 v[184:187], v18 offset:4096
    v_mfma_f32_16x16x32_bf16 v[152:155], v[216:219], v[204:207], v[152:155]
    ds_read_b128 v[188:191], v18 offset:6144
    v_mfma_f32_16x16x32_bf16 v[108:111], v[220:223], v[192:195], v[108:111]
    v_mfma_f32_16x16x32_bf16 v[124:127], v[220:223], v[196:199], v[124:127]
    v_mfma_f32_16x16x32_bf16 v[140:143], v[220:223], v[200:203], v[140:143]
    s_add_u32 m0, s77, s94
    s_nop 0
    buffer_load_dwordx4 v2, s[4:7], s73 offen sc1 lds
    v_mfma_f32_16x16x32_bf16 v[156:159], v[220:223], v[204:207], v[156:159]
    s_waitcnt lgkmcnt(0)
    v_mfma_f32_16x16x32_bf16 v[32:35], v[176:179], v[160:163], 0
    ds_read_b128 v[208:211], v19 offset:0
    v_mfma_f32_16x16x32_bf16 v[48:51], v[176:179], v[164:167], 0
    ds_read_b64_tr_b16 v[192:193], v16 offset:1024
    buffer_load_dwordx4 v2, s[4:7], s73 offen offset:1024 sc1 lds
    v_mfma_f32_16x16x32_bf16 v[64:67], v[176:179], v[168:171], 0
    ds_read_b64_tr_b16 v[194:195], v17 offset:1024
    v_mfma_f32_16x16x32_bf16 v[80:83], v[176:179], v[172:175], 0
    ds_read_b64_tr_b16 v[196:197], v16 offset:3072
    v_mfma_f32_16x16x32_bf16 v[36:39], v[180:183], v[160:163], 0
    ds_read_b64_tr_b16 v[198:199], v17 offset:3072
    v_mfma_f32_16x16x32_bf16 v[52:55], v[180:183], v[164:167], 0
    ds_read_b64_tr_b16 v[200:201], v16 offset:5120
    v_mfma_f32_16x16x32_bf16 v[68:71], v[180:183], v[168:171], 0
    ds_read_b64_tr_b16 v[202:203], v17 offset:5120
    s_add_u32 m0, s77, s95
    s_nop 0
    buffer_load_dwordx4 v3, s[8:11], s74 offen lds
    v_mfma_f32_16x16x32_bf16 v[84:87], v[180:183], v[172:175], 0
    ds_read_b64_tr_b16 v[204:205], v16 offset:7168
    v_mfma_f32_16x16x32_bf16 v[40:43], v[184:187], v[160:163], 0
    ds_read_b64_tr_b16 v[206:207], v17 offset:7168
    v_mfma_f32_16x16x32_bf16 v[56:59], v[184:187], v[164:167], 0
    ds_read_b128 v[212:215], v19 offset:2048
    v_mfma_f32_16x16x32_bf16 v[72:75], v[184:187], v[168:171], 0
    ds_read_b128 v[216:219], v19 offset:4096
    v_mfma_f32_16x16x32_bf16 v[88:91], v[184:187], v[172:175], 0
    ds_read_b128 v[220:223], v19 offset:6144
    v_mfma_f32_16x16x32_bf16 v[44:47], v[188:191], v[160:163], 0
    s_add_u32 m0, s77, s96
    s_nop 0
    buffer_load_dwordx4 v4, s[8:11], s74 offen lds
    s_add_u32 s72, s72, 1
    s_add_u32 s73, s73, 32768
    v_mfma_f32_16x16x32_bf16 v[60:63], v[188:191], v[164:167], 0
    v_mfma_f32_16x16x32_bf16 v[76:79], v[188:191], v[168:171], 0
    v_mfma_f32_16x16x32_bf16 v[92:95], v[188:191], v[172:175], 0
    s_waitcnt vmcnt(6) lgkmcnt(0)
    s_barrier
    v_add_u32 v16, s76, v7
    v_add_u32 v17, s76, v8
    v_add_u32 v18, s76, v9
    v_add_u32 v19, s76, v10
    v_mfma_f32_16x16x32_bf16 v[32:35], v[208:211], v[192:195], v[32:35]
    ds_read_b128 v[176:179], v18 offset:0
    s_mov_b32 s77, s75
    s_mov_b32 s75, s76
    s_add_u32 s76, s76, 49152
    s_cmp_lt_u32 s76, 147456
    s_cselect_b32 s76, s76, 0
    s_add_u32 s70, s70, 1
    v_mfma_f32_16x16x32_bf16 v[48:51], v[208:211], v[196:199], v[48:51]
    ds_read_b64_tr_b16 v[160:161], v16 offset:0
    s_bitcmp1_b32 s72, 0
    s_cselect_b64 s[8:9], s[44:45], s[42:43]
    s_lshr_b32 s80, s72, 1
    s_lshl_b32 s80, s80, 7
    s_add_u32 s74, s80, s97
    v_mfma_f32_16x16x32_bf16 v[64:67], v[208:211], v[200:203], v[64:67]
    ds_read_b64_tr_b16 v[162:163], v17 offset:0
    v_mfma_f32_16x16x32_bf16 v[80:83], v[208:211], v[204:207], v[80:83]
    ds_read_b64_tr_b16 v[164:165], v16 offset:2048
    v_mfma_f32_16x16x32_bf16 v[36:39], v[212:215], v[192:195], v[36:39]
    ds_read_b64_tr_b16 v[166:167], v17 offset:2048
    s_add_u32 m0, s77, s93
    s_nop 0
    buffer_load_dwordx4 v1, s[4:7], s73 offen sc1 lds
    v_mfma_f32_16x16x32_bf16 v[52:55], v[212:215], v[196:199], v[52:55]
    ds_read_b64_tr_b16 v[168:169], v16 offset:4096
    v_mfma_f32_16x16x32_bf16 v[68:71], v[212:215], v[200:203], v[68:71]
    ds_read_b64_tr_b16 v[170:171], v17 offset:4096
    v_mfma_f32_16x16x32_bf16 v[84:87], v[212:215], v[204:207], v[84:87]
    ds_read_b64_tr_b16 v[172:173], v16 offset:6144
    v_mfma_f32_16x16x32_bf16 v[40:43], v[216:219], v[192:195], v[40:43]
    ds_read_b64_tr_b16 v[174:175], v17 offset:6144
    v_mfma_f32_16x16x32_bf16 v[56:59], v[216:219], v[196:199], v[56:59]
    ds_read_b128 v[180:183], v18 offset:2048
    buffer_load_dwordx4 v1, s[4:7], s73 offen offset:1024 sc1 lds
    v_mfma_f32_16x16x32_bf16 v[72:75], v[216:219], v[200:203], v[72:75]
    ds_read_b128 v[184:187], v18 offset:4096
    v_mfma_f32_16x16x32_bf16 v[88:91], v[216:219], v[204:207], v[88:91]
    ds_read_b128 v[188:191], v18 offset:6144
    v_mfma_f32_16x16x32_bf16 v[44:47], v[220:223], v[192:195], v[44:47]
    v_mfma_f32_16x16x32_bf16 v[60:63], v[220:223], v[196:199], v[60:63]
    v_mfma_f32_16x16x32_bf16 v[76:79], v[220:223], v[200:203], v[76:79]
    s_add_u32 m0, s77, s94
    s_nop 0
    buffer_load_dwordx4 v2, s[4:7], s73 offen sc1 lds
    v_mfma_f32_16x16x32_bf16 v[92:95], v[220:223], v[204:207], v[92:95]
k2_la:
    s_waitcnt lgkmcnt(0)
    v_mfma_f32_16x16x32_bf16 v[32:35], v[176:179], v[160:163], v[32:35]
    ds_read_b128 v[208:211], v19 offset:0
    v_mfma_f32_16x16x32_bf16 v[48:51], v[176:179], v[164:167], v[48:51]
    ds_read_b64_tr_b16 v[192:193], v16 offset:1024
    buffer_load_dwordx4 v2, s[4:7], s73 offen offset:1024 sc1 lds
    v_mfma_f32_16x16x32_bf16 v[64:67], v[176:179], v[168:171], v[64:67]
    ds_read_b64_tr_b16 v[194:195], v17 offset:1024
    v_mfma_f32_16x16x32_bf16 v[80:83], v[176:179], v[172:175], v[80:83]
    ds_read_b64_tr_b16 v[196:197], v16 offset:3072
    v_mfma_f32_16x16x32_bf16 v[36:39], v[180:183], v[160:163], v[36:39]
    ds_read_b64_tr_b16 v[198:199], v17 offset:3072
    v_mfma_f32_16x16x32_bf16 v[52:55], v[180:183], v[164:167], v[52:55]
    ds_read_b64_tr_b16 v[200:201], v16 offset:5120
    v_mfma_f32_16x16x32_bf16 v[68:71], v[180:183], v[168:171], v[68:71]
    ds_read_b64_tr_b16 v[202:203], v17 offset:5120
    s_add_u32 m0, s77, s95
    s_nop 0
    buffer_load_dwordx4 v3, s[8:11], s74 offen lds
    v_mfma_f32_16x16x32_bf16 v[84:87], v[180:183], v[172:175], v[84:87]
    ds_read_b64_tr_b16 v[204:205], v16 offset:7168
    v_mfma_f32_16x16x32_bf16 v[40:43], v[184:187], v[160:163], v[40:43]
    ds_read_b64_tr_b16 v[206:207], v17 offset:7168
    v_mfma_f32_16x16x32_bf16 v[56:59], v[184:187], v[164:167], v[56:59]
    ds_read_b128 v[212:215], v19 offset:2048
    v_mfma_f32_16x16x32_bf16 v[72:75], v[184:187], v[168:171], v[72:75]
    ds_read_b128 v[216:219], v19 offset:4096
    v_mfma_f32_16x16x32_bf16 v[88:91], v[184:187], v[172:175], v[88:91]
    ds_read_b128 v[220:223], v19 offset:6144
    v_mfma_f32_16x16x32_bf16 v[44:47], v[188:191], v[160:163], v[44:47]
    s_add_u32 m0, s77, s96
    s_nop 0
    buffer_load_dwordx4 v4, s[8:11], s74 offen lds
    s_add_u32 s72, s72, 1
    s_add_u32 s73, s73, 32768
    v_mfma_f32_16x16x32_bf16 v[60:63], v[188:191], v[164:167], v[60:63]
    v_mfma_f32_16x16x32_bf16 v[76:79], v[188:191], v[168:171], v[76:79]
    v_mfma_f32_16x16x32_bf16 v[92:95], v[188:191], v[172:175], v[92:95]
    s_waitcnt vmcnt(6) lgkmcnt(0)
    s_barrier
    v_add_u32 v16, s76, v7
    v_add_u32 v17, s76, v8
    v_add_u32 v18, s76, v9
    v_add_u32 v19, s76, v10
    v_mfma_f32_16x16x32_bf16 v[32:35], v[208:211], v[192:195], v[32:35]
    ds_read_b128 v[176:179], v18 offset:0
    s_mov_b32 s77, s75
    s_mov_b32 s75, s76
    s_add_u32 s76, s76, 49152
    s_cmp_lt_u32 s76, 147456
    s_cselect_b32 s76, s76, 0
    s_add_u32 s70, s70, 1
    v_mfma_f32_16x16x32_bf16 v[48:51], v[208:211], v[196:199], v[48:51]
    ds_read_b64_tr_b16 v[160:161], v16 offset:0
    s_bitcmp1_b32 s72, 0
    s_cselect_b64 s[8:9], s[44:45], s[42:43]
    s_lshr_b32 s80, s72, 1
    s_lshl_b32 s80, s80, 7
    s_add_u32 s74, s80, s97
    v_mfma_f32_16x16x32_bf16 v[64:67], v[208:211], v[200:203], v[64:67]
    ds_read_b64_tr_b16 v[162:163], v17 offset:0
    v_mfma_f32_16x16x32_bf16 v[80:83], v[208:211], v[204:207], v[80:83]
    ds_read_b64_tr_b16 v[164:165], v16 offset:2048
    v_mfma_f32_16x16x32_bf16 v[36:39], v[212:215], v[192:195], v[36:39]
    ds_read_b64_tr_b16 v[166:167], v17 offset:2048
    s_add_u32 m0, s77, s93
    s_nop 0
    buffer_load_dwordx4 v1, s[4:7], s73 offen sc1 lds
    v_mfma_f32_16x16x32_bf16 v[52:55], v[212:215], v[196:199], v[52:55]
    ds_read_b64_tr_b16 v[168:169], v16 offset:4096
    v_mfma_f32_16x16x32_bf16 v[68:71], v[212:215], v[200:203], v[68:71]
    ds_read_b64_tr_b16 v[170:171], v17 offset:4096
    v_mfma_f32_16x16x32_bf16 v[84:87], v[212:215], v[204:207], v[84:87]
    ds_read_b64_tr_b16 v[172:173], v16 offset:6144
    v_mfma_f32_16x16x32_bf16 v[40:43], v[216:219], v[192:195], v[40:43]
    ds_read_b64_tr_b16 v[174:175], v17 offset:6144
    v_mfma_f32_16x16x32_bf16 v[56:59], v[216:219], v[196:199], v[56:59]
    ds_read_b128 v[180:183], v18 offset:2048
    buffer_load_dwordx4 v1, s[4:7], s73 offen offset:1024 sc1 lds
    v_mfma_f32_16x16x32_bf16 v[72:75], v[216:219], v[200:203], v[72:75]
    ds_read_b128 v[184:187], v18 offset:4096
    v_mfma_f32_16x16x32_bf16 v[88:91], v[216:219], v[204:207], v[88:91]
    ds_read_b128 v[188:191], v18 offset:6144
    v_mfma_f32_16x16x32_bf16 v[44:47], v[220:223], v[192:195], v[44:47]
    v_mfma_f32_16x16x32_bf16 v[60:63], v[220:223], v[196:199], v[60:63]
    v_mfma_f32_16x16x32_bf16 v[76:79], v[220:223], v[200:203], v[76:79]
    s_add_u32 m0, s77, s94
    s_nop 0
    buffer_load_dwordx4 v2, s[4:7], s73 offen sc1 lds
    v_mfma_f32_16x16x32_bf16 v[92:95], v[220:223], v[204:207], v[92:95]
    s_cmp_lt_u32 s70, 19
    s_cbranch_scc1 k2_la
    s_waitcnt lgkmcnt(0)
    v_mfma_f32_16x16x32_bf16 v[32:35], v[176:179], v[160:163], v[32:35]
    v_sub_f32 v26, 1.0, v224
    ds_read_b128 v[208:211], v19 offset:0
    v_mfma_f32_16x16x32_bf16 v[48:51], v[176:179], v[164:167], v[48:51]
    v_cvt_pk_bf16_f32 v26, v26, v26
    ds_read_b64_tr_b16 v[192:193], v16 offset:1024
    buffer_load_dwordx4 v2, s[4:7], s73 offen offset:1024 sc1 lds
    v_mfma_f32_16x16x32_bf16 v[64:67], v[176:179], v[168:171], v[64:67]
    v_lshlrev_b32 v26, 16, v26
    ds_read_b64_tr_b16 v[194:195], v17 offset:1024
    v_mfma_f32_16x16x32_bf16 v[80:83], v[176:179], v[172:175], v[80:83]
    v_sub_f32 v27, 1.0, v225
    ds_read_b64_tr_b16 v[196:197], v16 offset:3072
    v_mfma_f32_16x16x32_bf16 v[36:39], v[180:183], v[160:163], v[36:39]
    v_cvt_pk_bf16_f32 v27, v27, v27
    ds_read_b64_tr_b16 v[198:199], v17 offset:3072
    v_mfma_f32_16x16x32_bf16 v[52:55], v[180:183], v[164:167], v[52:55]
    v_lshlrev_b32 v27, 16, v27
    ds_read_b64_tr_b16 v[200:201], v16 offset:5120
    v_mfma_f32_16x16x32_bf16 v[68:71], v[180:183], v[168:171], v[68:71]
    v_sub_f32 v28, 1.0, v226
    ds_read_b64_tr_b16 v[202:203], v17 offset:5120
    s_add_u32 m0, s77, s95
    s_nop 0
    buffer_load_dwordx4 v3, s[8:11], s74 offen lds
    v_mfma_f32_16x16x32_bf16 v[84:87], v[180:183], v[172:175], v[84:87]
    v_cvt_pk_bf16_f32 v28, v28, v28
    ds_read_b64_tr_b16 v[204:205], v16 offset:7168
    v_mfma_f32_16x16x32_bf16 v[40:43], v[184:187], v[160:163], v[40:43]
    v_lshlrev_b32 v28, 16, v28
    ds_read_b64_tr_b16 v[206:207], v17 offset:7168
    v_mfma_f32_16x16x32_bf16 v[56:59], v[184:187], v[164:167], v[56:59]
    v_sub_f32 v29, 1.0, v227
    ds_read_b128 v[212:215], v19 offset:2048
    v_mfma_f32_16x16x32_bf16 v[72:75], v[184:187], v[168:171], v[72:75]
    v_cvt_pk_bf16_f32 v29, v29, v29
    ds_read_b128 v[216:219], v19 offset:4096
    v_mfma_f32_16x16x32_bf16 v[88:91], v[184:187], v[172:175], v[88:91]
    v_lshlrev_b32 v29, 16, v29
    ds_read_b128 v[220:223], v19 offset:6144
    v_mfma_f32_16x16x32_bf16 v[44:47], v[188:191], v[160:163], v[44:47]
    v_mul_f32 v96, v96, v26
    s_add_u32 m0, s77, s96
    s_nop 0
    buffer_load_dwordx4 v4, s[8:11], s74 offen lds
    s_add_u32 s72, s72, 1
    s_add_u32 s73, s73, 32768
    v_mfma_f32_16x16x32_bf16 v[60:63], v[188:191], v[164:167], v[60:63]
    v_mul_f32 v97, v97, v26
    v_mfma_f32_16x16x32_bf16 v[76:79], v[188:191], v[168:171], v[76:79]
    v_mfma_f32_16x16x32_bf16 v[92:95], v[188:191], v[172:175], v[92:95]
    s_waitcnt vmcnt(6) lgkmcnt(0)
    s_barrier
    v_add_u32 v16, s76, v7
    v_add_u32 v17, s76, v8
    v_add_u32 v18, s76, v9
    v_add_u32 v19, s76, v10
    v_mfma_f32_16x16x32_bf16 v[32:35], v[208:211], v[192:195], v[32:35]
    v_mul_f32 v98, v98, v26
    ds_read_b128 v[176:179], v18 offset:0
    s_mov_b32 s77, s75
    s_mov_b32 s75, s76
    s_add_u32 s76, s76, 49152
    s_cmp_lt_u32 s76, 147456
    s_cselect_b32 s76, s76, 0
    s_add_u32 s70, s70, 1
    v_mfma_f32_16x16x32_bf16 v[48:51], v[208:211], v[196:199], v[48:51]
    v_mul_f32 v99, v99, v26
    ds_read_b64_tr_b16 v[160:161], v16 offset:0
    v_mfma_f32_16x16x32_bf16 v[64:67], v[208:211], v[200:203], v[64:67]
    v_mul_f32 v100, v100, v26
    ds_read_b64_tr_b16 v[162:163], v17 offset:0
    v_mfma_f32_16x16x32_bf16 v[80:83], v[208:211], v[204:207], v[80:83]
    v_mul_f32 v101, v101, v26
    ds_read_b64_tr_b16 v[164:165], v16 offset:2048
    v_mfma_f32_16x16x32_bf16 v[36:39], v[212:215], v[192:195], v[36:39]
    v_mul_f32 v102, v102, v26
    ds_read_b64_tr_b16 v[166:167], v17 offset:2048
    v_mfma_f32_16x16x32_bf16 v[52:55], v[212:215], v[196:199], v[52:55]
    v_mul_f32 v103, v103, v26
    ds_read_b64_tr_b16 v[168:169], v16 offset:4096
    v_mfma_f32_16x16x32_bf16 v[68:71], v[212:215], v[200:203], v[68:71]
    v_mul_f32 v104, v104, v26
    ds_read_b64_tr_b16 v[170:171], v17 offset:4096
    v_mfma_f32_16x16x32_bf16 v[84:87], v[212:215], v[204:207], v[84:87]
    v_mul_f32 v105, v105, v26
    ds_read_b64_tr_b16 v[172:173], v16 offset:6144
    v_mfma_f32_16x16x32_bf16 v[40:43], v[216:219], v[192:195], v[40:43]
    v_mul_f32 v106, v106, v26
    ds_read_b64_tr_b16 v[174:175], v17 offset:6144
    v_mfma_f32_16x16x32_bf16 v[56:59], v[216:219], v[196:199], v[56:59]
    v_mul_f32 v107, v107, v26
    ds_read_b128 v[180:183], v18 offset:2048
    v_mfma_f32_16x16x32_bf16 v[72:75], v[216:219], v[200:203], v[72:75]
    v_mul_f32 v108, v108, v26
    ds_read_b128 v[184:187], v18 offset:4096
    v_mfma_f32_16x16x32_bf16 v[88:91], v[216:219], v[204:207], v[88:91]
    v_mul_f32 v109, v109, v26
    ds_read_b128 v[188:191], v18 offset:6144
    v_mfma_f32_16x16x32_bf16 v[44:47], v[220:223], v[192:195], v[44:47]
    v_mul_f32 v110, v110, v26
    v_mfma_f32_16x16x32_bf16 v[60:63], v[220:223], v[196:199], v[60:63]
    v_mul_f32 v111, v111, v26
    v_mfma_f32_16x16x32_bf16 v[76:79], v[220:223], v[200:203], v[76:79]
    v_mfma_f32_16x16x32_bf16 v[92:95], v[220:223], v[204:207], v[92:95]
    s_waitcnt lgkmcnt(0)
    v_mfma_f32_16x16x32_bf16 v[32:35], v[176:179], v[160:163], v[32:35]
    v_mul_f32 v112, v112, v27
    v_mul_f32 v113, v113, v27
    ds_read_b128 v[208:211], v19 offset:0
    v_mfma_f32_16x16x32_bf16 v[48:51], v[176:179], v[164:167], v[48:51]
    v_mul_f32 v114, v114, v27
    v_mul_f32 v115, v115, v27
    ds_read_b64_tr_b16 v[192:193], v16 offset:1024
    v_mfma_f32_16x16x32_bf16 v[64:67], v[176:179], v[168:171], v[64:67]
    v_mul_f32 v116, v116, v27
    v_mul_f32 v117, v117, v27
    ds_read_b64_tr_b16 v[194:195], v17 offset:1024
    v_mfma_f32_16x16x32_bf16 v[80:83], v[176:179], v[172:175], v[80:83]
    v_mul_f32 v118, v118, v27
    v_mul_f32 v119, v119, v27
    ds_read_b64_tr_b16 v[196:197], v16 offset:3072
    v_mfma_f32_16x16x32_bf16 v[36:39], v[180:183], v[160:163], v[36:39]
    v_mul_f32 v120, v120, v27
    v_mul_f32 v121, v121, v27
    ds_read_b64_tr_b16 v[198:199], v17 offset:3072
    v_mfma_f32_16x16x32_bf16 v[52:55], v[180:183], v[164:167], v[52:55]
    v_mul_f32 v122, v122, v27
    v_mul_f32 v123, v123, v27
    ds_read_b64_tr_b16 v[200:201], v16 offset:5120
    v_mfma_f32_16x16x32_bf16 v[68:71], v[180:183], v[168:171], v[68:71]
    v_mul_f32 v124, v124, v27
    v_mul_f32 v125, v125, v27
    ds_read_b64_tr_b16 v[202:203], v17 offset:5120
    v_mfma_f32_16x16x32_bf16 v[84:87], v[180:183], v[172:175], v[84:87]
    v_mul_f32 v126, v126, v27
    v_mul_f32 v127, v127, v27
    ds_read_b64_tr_b16 v[204:205], v16 offset:7168
    v_mfma_f32_16x16x32_bf16 v[40:43], v[184:187], v[160:163], v[40:43]
    v_mul_f32 v128, v128, v28
    v_mul_f32 v129, v129, v28
    ds_read_b64_tr_b16 v[206:207], v17 offset:7168
    v_mfma_f32_16x16x32_bf16 v[56:59], v[184:187], v[164:167], v[56:59]
    v_mul_f32 v130, v130, v28
    v_mul_f32 v131, v131, v28
    ds_read_b128 v[212:215], v19 offset:2048
    v_mfma_f32_16x16x32_bf16 v[72:75], v[184:187], v[168:171], v[72:75]
    v_mul_f32 v132, v132, v28
    v_mul_f32 v133, v133, v28
    ds_read_b128 v[216:219], v19 offset:4096
    v_mfma_f32_16x16x32_bf16 v[88:91], v[184:187], v[172:175], v[88:91]
    v_mul_f32 v134, v134, v28
    v_mul_f32 v135, v135, v28
    ds_read_b128 v[220:223], v19 offset:6144
    v_mfma_f32_16x16x32_bf16 v[44:47], v[188:191], v[160:163], v[44:47]
    v_mfma_f32_16x16x32_bf16 v[60:63], v[188:191], v[164:167], v[60:63]
    v_mfma_f32_16x16x32_bf16 v[76:79], v[188:191], v[168:171], v[76:79]
    v_mfma_f32_16x16x32_bf16 v[92:95], v[188:191], v[172:175], v[92:95]
    s_waitcnt vmcnt(0) lgkmcnt(0)
    s_barrier
    v_add_u32 v16, s76, v7
    v_add_u32 v17, s76, v8
    v_add_u32 v18, s76, v9
    v_add_u32 v19, s76, v10
    v_mfma_f32_16x16x32_bf16 v[32:35], v[208:211], v[192:195], v[32:35]
    v_mul_f32 v136, v136, v28
    v_mul_f32 v137, v137, v28
    ds_read_b128 v[176:179], v18 offset:0
    s_mov_b32 s77, s75
    s_mov_b32 s75, s76
    s_add_u32 s76, s76, 49152
    s_cmp_lt_u32 s76, 147456
    s_cselect_b32 s76, s76, 0
    s_add_u32 s70, s70, 1
    v_mfma_f32_16x16x32_bf16 v[48:51], v[208:211], v[196:199], v[48:51]
    v_mul_f32 v138, v138, v28
    v_mul_f32 v139, v139, v28
    ds_read_b64_tr_b16 v[160:161], v16 offset:0
    v_mfma_f32_16x16x32_bf16 v[64:67], v[208:211], v[200:203], v[64:67]
    v_mul_f32 v140, v140, v28
    v_mul_f32 v141, v141, v28
    ds_read_b64_tr_b16 v[162:163], v17 offset:0
    v_mfma_f32_16x16x32_bf16 v[80:83], v[208:211], v[204:207], v[80:83]
    v_mul_f32 v142, v142, v28
    v_mul_f32 v143, v143, v28
    ds_read_b64_tr_b16 v[164:165], v16 offset:2048
    v_mfma_f32_16x16x32_bf16 v[36:39], v[212:215], v[192:195], v[36:39]
    v_mul_f32 v144, v144, v29
    v_mul_f32 v145, v145, v29
    ds_read_b64_tr_b16 v[166:167], v17 offset:2048
    v_mfma_f32_16x16x32_bf16 v[52:55], v[212:215], v[196:199], v[52:55]
    v_mul_f32 v146, v146, v29
    v_mul_f32 v147, v147, v29
    ds_read_b64_tr_b16 v[168:169], v16 offset:4096
    v_mfma_f32_16x16x32_bf16 v[68:71], v[212:215], v[200:203], v[68:71]
    v_mul_f32 v148, v148, v29
    v_mul_f32 v149, v149, v29
    ds_read_b64_tr_b16 v[170:171], v17 offset:4096
    v_mfma_f32_16x16x32_bf16 v[84:87], v[212:215], v[204:207], v[84:87]
    v_mul_f32 v150, v150, v29
    v_mul_f32 v151, v151, v29
    ds_read_b64_tr_b16 v[172:173], v16 offset:6144
    v_mfma_f32_16x16x32_bf16 v[40:43], v[216:219], v[192:195], v[40:43]
    v_mul_f32 v152, v152, v29
    v_mul_f32 v153, v153, v29
    ds_read_b64_tr_b16 v[174:175], v17 offset:6144
    v_mfma_f32_16x16x32_bf16 v[56:59], v[216:219], v[196:199], v[56:59]
    v_mul_f32 v154, v154, v29
    v_mul_f32 v155, v155, v29
    ds_read_b128 v[180:183], v18 offset:2048
    v_mfma_f32_16x16x32_bf16 v[72:75], v[216:219], v[200:203], v[72:75]
    v_mul_f32 v156, v156, v29
    v_mul_f32 v157, v157, v29
    ds_read_b128 v[184:187], v18 offset:4096
    v_mfma_f32_16x16x32_bf16 v[88:91], v[216:219], v[204:207], v[88:91]
    v_mul_f32 v158, v158, v29
    v_mul_f32 v159, v159, v29
    ds_read_b128 v[188:191], v18 offset:6144
    v_mfma_f32_16x16x32_bf16 v[44:47], v[220:223], v[192:195], v[44:47]
    v_mfma_f32_16x16x32_bf16 v[60:63], v[220:223], v[196:199], v[60:63]
    v_mfma_f32_16x16x32_bf16 v[76:79], v[220:223], v[200:203], v[76:79]
    v_mfma_f32_16x16x32_bf16 v[92:95], v[220:223], v[204:207], v[92:95]
    s_waitcnt lgkmcnt(0)
    v_mfma_f32_16x16x32_bf16 v[32:35], v[176:179], v[160:163], v[32:35]
    ds_read_b128 v[208:211], v19 offset:0
    v_mfma_f32_16x16x32_bf16 v[48:51], v[176:179], v[164:167], v[48:51]
    ds_read_b64_tr_b16 v[192:193], v16 offset:1024
    v_mfma_f32_16x16x32_bf16 v[64:67], v[176:179], v[168:171], v[64:67]
    ds_read_b64_tr_b16 v[194:195], v17 offset:1024
    v_mfma_f32_16x16x32_bf16 v[80:83], v[176:179], v[172:175], v[80:83]
    ds_read_b64_tr_b16 v[196:197], v16 offset:3072
    v_mfma_f32_16x16x32_bf16 v[36:39], v[180:183], v[160:163], v[36:39]
    ds_read_b64_tr_b16 v[198:199], v17 offset:3072
    v_mfma_f32_16x16x32_bf16 v[52:55], v[180:183], v[164:167], v[52:55]
    ds_read_b64_tr_b16 v[200:201], v16 offset:5120
    v_mfma_f32_16x16x32_bf16 v[68:71], v[180:183], v[168:171], v[68:71]
    ds_read_b64_tr_b16 v[202:203], v17 offset:5120
    v_mfma_f32_16x16x32_bf16 v[84:87], v[180:183], v[172:175], v[84:87]
    ds_read_b64_tr_b16 v[204:205], v16 offset:7168
    v_mfma_f32_16x16x32_bf16 v[40:43], v[184:187], v[160:163], v[40:43]
    ds_read_b64_tr_b16 v[206:207], v17 offset:7168
    v_mfma_f32_16x16x32_bf16 v[56:59], v[184:187], v[164:167], v[56:59]
    ds_read_b128 v[212:215], v19 offset:2048
    v_mfma_f32_16x16x32_bf16 v[72:75], v[184:187], v[168:171], v[72:75]
    ds_read_b128 v[216:219], v19 offset:4096
    v_mfma_f32_16x16x32_bf16 v[88:91], v[184:187], v[172:175], v[88:91]
    ds_read_b128 v[220:223], v19 offset:6144
    v_mfma_f32_16x16x32_bf16 v[44:47], v[188:191], v[160:163], v[44:47]
    v_mfma_f32_16x16x32_bf16 v[60:63], v[188:191], v[164:167], v[60:63]
    v_mfma_f32_16x16x32_bf16 v[76:79], v[188:191], v[168:171], v[76:79]
    v_mfma_f32_16x16x32_bf16 v[92:95], v[188:191], v[172:175], v[92:95]
    s_waitcnt lgkmcnt(0)
    v_mfma_f32_16x16x32_bf16 v[48:51], v[208:211], v[196:199], v[48:51]
    v_mfma_f32_16x16x32_bf16 v[52:55], v[212:215], v[196:199], v[52:55]
    v_mfma_f32_16x16x32_bf16 v[56:59], v[216:219], v[196:199], v[56:59]
    v_mfma_f32_16x16x32_bf16 v[60:63], v[220:223], v[196:199], v[60:63]
    v_mfma_f32_16x16x32_bf16 v[64:67], v[208:211], v[200:203], v[64:67]
    v_mfma_f32_16x16x32_bf16 v[68:71], v[212:215], v[200:203], v[68:71]
    v_mfma_f32_16x16x32_bf16 v[72:75], v[216:219], v[200:203], v[72:75]
    v_mfma_f32_16x16x32_bf16 v[76:79], v[220:223], v[200:203], v[76:79]
    v_mfma_f32_16x16x32_bf16 v[80:83], v[208:211], v[204:207], v[80:83]
    v_mfma_f32_16x16x32_bf16 v[84:87], v[212:215], v[204:207], v[84:87]
    v_mfma_f32_16x16x32_bf16 v[88:91], v[216:219], v[204:207], v[88:91]
    v_mfma_f32_16x16x32_bf16 v[92:95], v[220:223], v[204:207], v[92:95]
    v_mfma_f32_16x16x32_bf16 v[32:35], v[208:211], v[192:195], v[32:35]
    v_mfma_f32_16x16x32_bf16 v[36:39], v[212:215], v[192:195], v[36:39]
    v_mfma_f32_16x16x32_bf16 v[40:43], v[216:219], v[192:195], v[40:43]
    v_mfma_f32_16x16x32_bf16 v[44:47], v[220:223], v[192:195], v[44:47]
k2_epi:
    s_mov_b32 s24, s58
    s_mov_b32 s25, s59
    s_mov_b32 s26, 8388608
    s_mov_b32 s27, 0x00020000
    s_lshl_b32 s80, s67, 3
    s_add_u32 s88, s80, s78
    s_lshl_b32 s80, s88, 18
    s_add_u32 s80, s80, 33554432
    s_lshl_b32 s81, s64, 11
    s_add_u32 s89, s80, s81
    s_lshl_b32 s81, s69, 14
    s_add_u32 s90, s89, s81
    v_lshlrev_b32 v25, 4, v0
    s_waitcnt lgkmcnt(0)
    v_fma_f32 v48, v48, v225, v112
    v_fma_f32 v49, v49, v225, v113
    v_fma_f32 v50, v50, v225, v114
    v_fma_f32 v51, v51, v225, v115
    v_fma_f32 v52, v52, v225, v116
    v_fma_f32 v53, v53, v225, v117
    v_fma_f32 v54, v54, v225, v118
    v_fma_f32 v55, v55, v225, v119
    v_fma_f32 v56, v56, v225, v120
    v_fma_f32 v57, v57, v225, v121
    v_fma_f32 v58, v58, v225, v122
    v_fma_f32 v59, v59, v225, v123
    v_fma_f32 v60, v60, v225, v124
    v_fma_f32 v61, v61, v225, v125
    v_fma_f32 v62, v62, v225, v126
    v_fma_f32 v63, v63, v225, v127
    s_add_u32 s81, s69, 1
    s_and_b32 s81, s81, 3
    s_lshl_b32 s81, s81, 16
    s_add_u32 s81, s81, s90
    v_cvt_pk_bf16_f32 v168, v48, v49
    v_cvt_pk_bf16_f32 v169, v50, v51
    v_cvt_pk_bf16_f32 v170, v52, v53
    v_cvt_pk_bf16_f32 v171, v54, v55
    v_cvt_pk_bf16_f32 v172, v56, v57
    v_cvt_pk_bf16_f32 v173, v58, v59
    v_cvt_pk_bf16_f32 v174, v60, v61
    v_cvt_pk_bf16_f32 v175, v62, v63
    buffer_store_dwordx4 v[168:171], v25, s[12:15], s81 offen offset:0 sc1
    buffer_store_dwordx4 v[172:175], v25, s[12:15], s81 offen offset:1024 sc1
    v_fma_f32 v64, v64, v226, v128
    v_fma_f32 v65, v65, v226, v129
    v_fma_f32 v66, v66, v226, v130
    v_fma_f32 v67, v67, v226, v131
    v_fma_f32 v68, v68, v226, v132
    v_fma_f32 v69, v69, v226, v133
    v_fma_f32 v70, v70, v226, v134
    v_fma_f32 v71, v71, v226, v135
    v_fma_f32 v72, v72, v226, v136
    v_fma_f32 v73, v73, v226, v137
    v_fma_f32 v74, v74, v226, v138
    v_fma_f32 v75, v75, v226, v139
    v_fma_f32 v76, v76, v226, v140
    v_fma_f32 v77, v77, v226, v141
    v_fma_f32 v78, v78, v226, v142
    v_fma_f32 v79, v79, v226, v143
    s_add_u32 s81, s69, 2
    s_and_b32 s81, s81, 3
    s_lshl_b32 s81, s81, 16
    s_add_u32 s81, s81, s90
    v_cvt_pk_bf16_f32 v176, v64, v65
    v_cvt_pk_bf16_f32 v177, v66, v67
    v_cvt_pk_bf16_f32 v178, v68, v69
    v_cvt_pk_bf16_f32 v179, v70, v71
    v_cvt_pk_bf16_f32 v180, v72, v73
    v_cvt_pk_bf16_f32 v181, v74, v75
    v_cvt_pk_bf16_f32 v182, v76, v77
    v_cvt_pk_bf16_f32 v183, v78, v79
    buffer_store_dwordx4 v[176:179], v25, s[12:15], s81 offen offset:0 sc1
    buffer_store_dwordx4 v[180:183], v25, s[12:15], s81 offen offset:1024 sc1
    v_fma_f32 v80, v80, v227, v144
    v_fma_f32 v81, v81, v227, v145
    v_fma_f32 v82, v82, v227, v146
    v_fma_f32 v83, v83, v227, v147
    v_fma_f32 v84, v84, v227, v148
    v_fma_f32 v85, v85, v227, v149
    v_fma_f32 v86, v86, v227, v150
    v_fma_f32 v87, v87, v227, v151
    v_fma_f32 v88, v88, v227, v152
    v_fma_f32 v89, v89, v227, v153
    v_fma_f32 v90, v90, v227, v154
    v_fma_f32 v91, v91, v227, v155
    v_fma_f32 v92, v92, v227, v156
    v_fma_f32 v93, v93, v227, v157
    v_fma_f32 v94, v94, v227, v158
    v_fma_f32 v95, v95, v227, v159
    s_add_u32 s81, s69, 3
    s_and_b32 s81, s81, 3
    s_lshl_b32 s81, s81, 16
    s_add_u32 s81, s81, s90
    v_cvt_pk_bf16_f32 v184, v80, v81
    v_cvt_pk_bf16_f32 v185, v82, v83
    v_cvt_pk_bf16_f32 v186, v84, v85
    v_cvt_pk_bf16_f32 v187, v86, v87
    v_cvt_pk_bf16_f32 v188, v88, v89
    v_cvt_pk_bf16_f32 v189, v90, v91
    v_cvt_pk_bf16_f32 v190, v92, v93
    v_cvt_pk_bf16_f32 v191, v94, v95
    buffer_store_dwordx4 v[184:187], v25, s[12:15], s81 offen offset:0 sc1
    buffer_store_dwordx4 v[188:191], v25, s[12:15], s81 offen offset:1024 sc1
    v_fma_f32 v32, v32, v224, v96
    v_fma_f32 v33, v33, v224, v97
    v_fma_f32 v34, v34, v224, v98
    v_fma_f32 v35, v35, v224, v99
    v_fma_f32 v36, v36, v224, v100
    v_fma_f32 v37, v37, v224, v101
    v_fma_f32 v38, v38, v224, v102
    v_fma_f32 v39, v39, v224, v103
    v_fma_f32 v40, v40, v224, v104
    v_fma_f32 v41, v41, v224, v105
    v_fma_f32 v42, v42, v224, v106
    v_fma_f32 v43, v43, v224, v107
    v_fma_f32 v44, v44, v224, v108
    v_fma_f32 v45, v45, v224, v109
    v_fma_f32 v46, v46, v224, v110
    v_fma_f32 v47, v47, v224, v111
    v_lshlrev_b32 v192, 16, v228
    v_and_b32 v193, 0xffff0000, v228
    v_lshlrev_b32 v194, 16, v236
    v_and_b32 v195, 0xffff0000, v236
    v_mul_f32 v192, v192, v194
    v_mul_f32 v193, v193, v195
    v_cvt_pk_bf16_f32 v192, v192, v193
    v_lshlrev_b32 v193, 16, v192
    v_and_b32 v192, 0xffff0000, v192
    v_fmac_f32 v32, v193, v224
    v_fmac_f32 v33, v192, v224
    v_lshlrev_b32 v192, 16, v229
    v_and_b32 v193, 0xffff0000, v229
    v_lshlrev_b32 v194, 16, v237
    v_and_b32 v195, 0xffff0000, v237
    v_mul_f32 v192, v192, v194
    v_mul_f32 v193, v193, v195
    v_cvt_pk_bf16_f32 v192, v192, v193
    v_lshlrev_b32 v193, 16, v192
    v_and_b32 v192, 0xffff0000, v192
    v_fmac_f32 v34, v193, v224
    v_fmac_f32 v35, v192, v224
    v_lshlrev_b32 v192, 16, v230
    v_and_b32 v193, 0xffff0000, v230
    v_lshlrev_b32 v194, 16, v238
    v_and_b32 v195, 0xffff0000, v238
    v_mul_f32 v192, v192, v194
    v_mul_f32 v193, v193, v195
    v_cvt_pk_bf16_f32 v192, v192, v193
    v_lshlrev_b32 v193, 16, v192
    v_and_b32 v192, 0xffff0000, v192
    v_fmac_f32 v36, v193, v224
    v_fmac_f32 v37, v192, v224
    v_lshlrev_b32 v192, 16, v231
    v_and_b32 v193, 0xffff0000, v231
    v_lshlrev_b32 v194, 16, v239
    v_and_b32 v195, 0xffff0000, v239
    v_mul_f32 v192, v192, v194
    v_mul_f32 v193, v193, v195
    v_cvt_pk_bf16_f32 v192, v192, v193
    v_lshlrev_b32 v193, 16, v192
    v_and_b32 v192, 0xffff0000, v192
    v_fmac_f32 v38, v193, v224
    v_fmac_f32 v39, v192, v224
    v_lshlrev_b32 v192, 16, v232
    v_and_b32 v193, 0xffff0000, v232
    v_lshlrev_b32 v194, 16, v240
    v_and_b32 v195, 0xffff0000, v240
    v_mul_f32 v192, v192, v194
    v_mul_f32 v193, v193, v195
    v_cvt_pk_bf16_f32 v192, v192, v193
    v_lshlrev_b32 v193, 16, v192
    v_and_b32 v192, 0xffff0000, v192
    v_fmac_f32 v40, v193, v224
    v_fmac_f32 v41, v192, v224
    v_lshlrev_b32 v192, 16, v233
    v_and_b32 v193, 0xffff0000, v233
    v_lshlrev_b32 v194, 16, v241
    v_and_b32 v195, 0xffff0000, v241
    v_mul_f32 v192, v192, v194
    v_mul_f32 v193, v193, v195
    v_cvt_pk_bf16_f32 v192, v192, v193
    v_lshlrev_b32 v193, 16, v192
    v_and_b32 v192, 0xffff0000, v192
    v_fmac_f32 v42, v193, v224
    v_fmac_f32 v43, v192, v224
    v_lshlrev_b32 v192, 16, v234
    v_and_b32 v193, 0xffff0000, v234
    v_lshlrev_b32 v194, 16, v242
    v_and_b32 v195, 0xffff0000, v242
    v_mul_f32 v192, v192, v194
    v_mul_f32 v193, v193, v195
    v_cvt_pk_bf16_f32 v192, v192, v193
    v_lshlrev_b32 v193, 16, v192
    v_and_b32 v192, 0xffff0000, v192
    v_fmac_f32 v44, v193, v224
    v_fmac_f32 v45, v192, v224
    v_lshlrev_b32 v192, 16, v235
    v_and_b32 v193, 0xffff0000, v235
    v_lshlrev_b32 v194, 16, v243
    v_and_b32 v195, 0xffff0000, v243
    v_mul_f32 v192, v192, v194
    v_mul_f32 v193, v193, v195
    v_cvt_pk_bf16_f32 v192, v192, v193
    v_lshlrev_b32 v193, 16, v192
    v_and_b32 v192, 0xffff0000, v192
    v_fmac_f32 v46, v193, v224
    v_fmac_f32 v47, v192, v224
    s_lshl_b32 s80, s88, 12
    s_lshl_b32 s81, s64, 7
    s_add_u32 s80, s80, s81
    s_add_u32 s80, s80, 23330816
    s_lshl_b32 s81, s69, 10
    s_add_u32 s81, s81, s80
    v_mov_b32 v192, 0
    v_mov_b32 v193, s100
    v_and_b32 v194, 3, v0
    v_lshlrev_b32 v194, 10, v194
    s_lshl_b32 s86, 1, s69
    s_xor_b32 s86, s86, 15
    s_mov_b32 s87, 0
    s_mov_b64 exec, s[86:87]
    buffer_load_dword v195, v194, s[12:15], s80 offen sc1
    s_waitcnt vmcnt(1)
    s_mov_b64 exec, 1
    buffer_store_dword v193, v192, s[12:15], s81 offen sc1
    s_mov_b64 exec, s[86:87]
    s_lshl_b32 s81, s69, 16
    s_add_u32 s89, s89, s81
    s_waitcnt vmcnt(1)
k2_poll:
    v_cmp_ne_u32 vcc, s100, v195
    s_nop 3
    s_cbranch_vccz k2_nopoll
    s_sleep 1
    buffer_load_dword v195, v194, s[12:15], s80 offen sc1
    s_waitcnt vmcnt(0)
    s_branch k2_poll
k2_nopoll:
    s_mov_b64 exec, -1
    s_add_u32 s81, s69, 1
    s_and_b32 s81, s81, 3
    s_lshl_b32 s81, s81, 14
    s_add_u32 s81, s81, s89
    buffer_load_dwordx4 v[168:171], v25, s[12:15], s81 offen offset:0 sc1
    buffer_load_dwordx4 v[172:175], v25, s[12:15], s81 offen offset:1024 sc1
    s_add_u32 s81, s69, 2
    s_and_b32 s81, s81, 3
    s_lshl_b32 s81, s81, 14
    s_add_u32 s81, s81, s89
    buffer_load_dwordx4 v[176:179], v25, s[12:15], s81 offen offset:0 sc1
    buffer_load_dwordx4 v[180:183], v25, s[12:15], s81 offen offset:1024 sc1
    s_add_u32 s81, s69, 3
    s_and_b32 s81, s81, 3
    s_lshl_b32 s81, s81, 14
    s_add_u32 s81, s81, s89
    buffer_load_dwordx4 v[184:187], v25, s[12:15], s81 offen offset:0 sc1
    buffer_load_dwordx4 v[188:191], v25, s[12:15], s81 offen offset:1024 sc1
    s_waitcnt vmcnt(0)
    v_lshlrev_b32 v192, 16, v168
    v_and_b32 v193, 0xffff0000, v168
    v_add_f32 v32, v32, v192
    v_add_f32 v33, v33, v193
    v_lshlrev_b32 v192, 16, v176
    v_and_b32 v193, 0xffff0000, v176
    v_add_f32 v32, v32, v192
    v_add_f32 v33, v33, v193
    v_lshlrev_b32 v192, 16, v184
    v_and_b32 v193, 0xffff0000, v184
    v_add_f32 v32, v32, v192
    v_add_f32 v33, v33, v193
    v_lshlrev_b32 v192, 16, v169
    v_and_b32 v193, 0xffff0000, v169
    v_add_f32 v34, v34, v192
    v_add_f32 v35, v35, v193
    v_lshlrev_b32 v192, 16, v177
    v_and_b32 v193, 0xffff0000, v177
    v_add_f32 v34, v34, v192
    v_add_f32 v35, v35, v193
    v_lshlrev_b32 v192, 16, v185
    v_and_b32 v193, 0xffff0000, v185
    v_add_f32 v34, v34, v192
    v_add_f32 v35, v35, v193
    buffer_store_dwordx4 v[32:35], v31, s[24:27], 0 offen offset:0 nt
    v_lshlrev_b32 v192, 16, v170
    v_and_b32 v193, 0xffff0000, v170
    v_add_f32 v36, v36, v192
    v_add_f32 v37, v37, v193
    v_lshlrev_b32 v192, 16, v178
    v_and_b32 v193, 0xffff0000, v178
    v_add_f32 v36, v36, v192
    v_add_f32 v37, v37, v193
    v_lshlrev_b32 v192, 16, v186
    v_and_b32 v193, 0xffff0000, v186
    v_add_f32 v36, v36, v192
    v_add_f32 v37, v37, v193
    v_lshlrev_b32 v192, 16, v171
    v_and_b32 v193, 0xffff0000, v171
    v_add_f32 v38, v38, v192
    v_add_f32 v39, v39, v193
    v_lshlrev_b32 v192, 16, v179
    v_and_b32 v193, 0xffff0000, v179
    v_add_f32 v38, v38, v192
    v_add_f32 v39, v39, v193
    v_lshlrev_b32 v192, 16, v187
    v_and_b32 v193, 0xffff0000, v187
    v_add_f32 v38, v38, v192
    v_add_f32 v39, v39, v193
    buffer_store_dwordx4 v[36:39], v31, s[24:27], 0 offen offset:64 nt
    v_lshlrev_b32 v192, 16, v172
    v_and_b32 v193, 0xffff0000, v172
    v_add_f32 v40, v40, v192
    v_add_f32 v41, v41, v193
    v_lshlrev_b32 v192, 16, v180
    v_and_b32 v193, 0xffff0000, v180
    v_add_f32 v40, v40, v192
    v_add_f32 v41, v41, v193
    v_lshlrev_b32 v192, 16, v188
    v_and_b32 v193, 0xffff0000, v188
    v_add_f32 v40, v40, v192
    v_add_f32 v41, v41, v193
    v_lshlrev_b32 v192, 16, v173
    v_and_b32 v193, 0xffff0000, v173
    v_add_f32 v42, v42, v192
    v_add_f32 v43, v43, v193
    v_lshlrev_b32 v192, 16, v181
    v_and_b32 v193, 0xffff0000, v181
    v_add_f32 v42, v42, v192
    v_add_f32 v43, v43, v193
    v_lshlrev_b32 v192, 16, v189
    v_and_b32 v193, 0xffff0000, v189
    v_add_f32 v42, v42, v192
    v_add_f32 v43, v43, v193
    buffer_store_dwordx4 v[40:43], v31, s[24:27], 0 offen offset:128 nt
    v_lshlrev_b32 v192, 16, v174
    v_and_b32 v193, 0xffff0000, v174
    v_add_f32 v44, v44, v192
    v_add_f32 v45, v45, v193
    v_lshlrev_b32 v192, 16, v182
    v_and_b32 v193, 0xffff0000, v182
    v_add_f32 v44, v44, v192
    v_add_f32 v45, v45, v193
    v_lshlrev_b32 v192, 16, v190
    v_and_b32 v193, 0xffff0000, v190
    v_add_f32 v44, v44, v192
    v_add_f32 v45, v45, v193
    v_lshlrev_b32 v192, 16, v175
    v_and_b32 v193, 0xffff0000, v175
    v_add_f32 v46, v46, v192
    v_add_f32 v47, v47, v193
    v_lshlrev_b32 v192, 16, v183
    v_and_b32 v193, 0xffff0000, v183
    v_add_f32 v46, v46, v192
    v_add_f32 v47, v47, v193
    v_lshlrev_b32 v192, 16, v191
    v_and_b32 v193, 0xffff0000, v191
    v_add_f32 v46, v46, v192
    v_add_f32 v47, v47, v193
    buffer_store_dwordx4 v[44:47], v31, s[24:27], 0 offen offset:192 nt
k1_end:
    s_endpgm
.section .rodata,"a"
.p2align 6
.amdhsa_kernel gated_mix__ssm_conv_s5__dense_activation_relu__prompt_kernel
  .amdhsa_next_free_vgpr 256
  .amdhsa_next_free_sgpr 102
  .amdhsa_accum_offset 256
  .amdhsa_group_segment_fixed_size 0
  .amdhsa_kernarg_size 128
  .amdhsa_user_sgpr_count 2
  .amdhsa_user_sgpr_kernarg_segment_ptr 1
  .amdhsa_system_sgpr_workgroup_id_x 1
.end_amdhsa_kernel
```
